```python
import torch

def _softmax(x, axis=-1):
    return torch.softmax(x, dim=axis)
def _gelu(x):
    return torch.nn.functional.gelu(x, approximate="tanh")
def _silu(x):
    return torch.nn.functional.silu(x)
def _sigmoid(x):
    return torch.sigmoid(x)
def _layernorm(x, axis=-1, eps=1e-5):
    m = x.mean(dim=axis, keepdim=True)
    v = x.var(dim=axis, keepdim=True, unbiased=False)
    return (x - m) / torch.sqrt(v + eps)
def _scatter_add(tgt, idx, src, axis=0):
    return tgt.clone().index_add_(axis, idx, src)
def _segment_sum(src, seg, n):
    out = torch.zeros((n,) + src.shape[1:], dtype=src.dtype)
    return out.index_add_(0, seg, src)
def _pad(x, pw):
    flat = tuple(v for pair in reversed(pw) for v in pair)
    return torch.nn.functional.pad(x, flat)

kernel_name = 'concat_heads__ssm_conv_s4d__linear_kernel_hedgehog__prompt'

def setup_inputs():

    _w = (lambda a: (lambda t: t.to(torch.bfloat16) if t.is_floating_point() else t)(torch.as_tensor(a)))
    def _A_setup():
        Bsz, L, D, N = 1, 2048, 448, 256
        return {
            "u": _w((lambda *s: torch.randn(*s, dtype=torch.bfloat16) * 0.05)(Bsz, L, D)),
            "log_A_real": _w((lambda *s: torch.randn(*s, dtype=torch.bfloat16) * 6.4)(D, N) * 0.5),
            "A_imag": _w((lambda *s: torch.randn(*s, dtype=torch.bfloat16) * 0.2)(D, N) * 3.14),
            "C_real": _w((lambda *s: torch.randn(*s, dtype=torch.bfloat16) * 0.8)(D, N) / N ** 0.5),
            "C_imag": _w((lambda *s: torch.randn(*s, dtype=torch.bfloat16) * 0.8)(D, N) / N ** 0.5),
            "log_dt": _w((lambda *s: torch.randn(*s, dtype=torch.bfloat16) * 0.2)(D) * 0.5 - 4.0),
            "D_skip": _w((lambda *s: torch.randn(*s, dtype=torch.bfloat16) * 0.2)(D)),
        }
    _A_in = _A_setup()

    def _B_setup():
        B, S, D, H = 1, 2048, 448, 16
        Dh = D // H
        return {
            "x": _w((lambda *s: torch.randn(*s, dtype=torch.bfloat16) * 0.4)(B, S, D)),
            "wqkv": _w((lambda *s: torch.randn(*s, dtype=torch.bfloat16) * 0.4)(D, 3 * D)),
            "w_phi": _w((lambda *s: torch.randn(*s, dtype=torch.bfloat16) * 0.4)(H, Dh, Dh) * (Dh ** -0.5)),
            "wo": _w((lambda *s: torch.randn(*s, dtype=torch.bfloat16) * 0.05)(D, D)),
        }
    _B_in = _B_setup()

    return {
        "A_u": _A_in["u"],
        "A_log_A_real": _A_in["log_A_real"],
        "A_A_imag": _A_in["A_imag"],
        "A_C_real": _A_in["C_real"],
        "A_C_imag": _A_in["C_imag"],
        "A_log_dt": _A_in["log_dt"],
        "A_D_skip": _A_in["D_skip"],
        "B_x": _B_in["x"],
        "B_wqkv": _B_in["wqkv"],
        "B_w_phi": _B_in["w_phi"],
        "B_wo": _B_in["wo"],
    }

def reference(A_u, A_log_A_real, A_A_imag, A_C_real, A_C_imag, A_log_dt, A_D_skip, B_x, B_wqkv, B_w_phi, B_wo):
    def _A_ref(u, log_A_real, A_imag, C_real, C_imag, log_dt, D_skip):
        L = u.shape[1]
        dt = torch.exp(log_dt)
        A = -torch.exp(log_A_real) + 1j * A_imag
        C = (C_real + 1j * C_imag) * dt[:, None]
        pos = (lambda x, dt: x.to(dt))(torch.arange(L), log_dt.dtype)
        P = torch.exp((A * dt[:, None])[:, :, None] * pos[None, None, :])
        K = 2.0 * torch.einsum("dn,dnl->dl", C, P).real
        L2 = 2 * L
        u_t = (lambda x, *d: x.permute(*d))(u, 0, 2, 1)
        Kf = (lambda x, *a, **k: torch.fft.rfft(x.float(), *a, **k))(K, L2)
        Uf = (lambda x, *a, **k: torch.fft.rfft(x.float(), *a, **k))(u_t, L2)
        y = (lambda x, *a, **k: torch.fft.irfft(x, *a, **k).to(torch.bfloat16))(Uf * Kf[None, :, :], L2)[:, :, :L]
        y = (lambda x, *d: x.permute(*d))(y, 0, 2, 1)
        return y + u * D_skip[None, None, :]

    def _B_ref(x, wqkv, w_phi, wo):
        B, S, D = x.shape
        H = 16; Dh = D // H
        qkv = (lambda x, *d: x.permute(*d))((x @ wqkv).reshape(B, S, 3, H, Dh), 2, 0, 3, 1, 4)
        q, k, v = qkv[0], qkv[1], qkv[2]
        pq = torch.einsum("bhsd,hdf->bhsf", q, w_phi)
        pk = torch.einsum("bhsd,hdf->bhsf", k, w_phi)
        phi_q = torch.concatenate([_softmax(pq, axis=-1), _softmax(-pq, axis=-1)], axis=-1)
        phi_k = torch.concatenate([_softmax(pk, axis=-1), _softmax(-pk, axis=-1)], axis=-1)
        kv = torch.einsum("bhsf,bhsd->bhfd", phi_k, v)
        z  = torch.einsum("bhsf->bhf", phi_k)
        num = torch.einsum("bhqf,bhfd->bhqd", phi_q, kv)
        den = torch.einsum("bhqf,bhf->bhq", phi_q, z)[..., None] + 1e-6
        o = num / den
        return (lambda x, *d: x.permute(*d))(o, 0, 2, 1, 3).reshape(B, S, D) @ wo

    a = _A_ref(A_u, A_log_A_real, A_A_imag, A_C_real, A_C_imag, A_log_dt, A_D_skip)
    b = _B_ref(B_x, B_wqkv, B_w_phi, B_wo)
    return torch.concatenate([a, b], axis=-1)
```

```asm
; @launch kernel=concat_heads__ssm_conv_s4d__linear_kernel_hedgehog__prompt_kernel grid=(718,1,1) block=(256,1,1) lds=57408
; @launch kernel=concat_heads__ssm_conv_s4d__linear_kernel_hedgehog__prompt_s2_kernel grid=(128,1,1) block=(256,1,1) lds=32768
.amdgcn_target "amdgcn-amd-amdhsa--gfx950"
.text
.globl concat_heads__ssm_conv_s4d__linear_kernel_hedgehog__prompt_kernel
.p2align 8
.type concat_heads__ssm_conv_s4d__linear_kernel_hedgehog__prompt_kernel,@function
concat_heads__ssm_conv_s4d__linear_kernel_hedgehog__prompt_kernel:
    s_load_dwordx16 s[16:31], s[0:1], 0
    s_load_dwordx8 s[32:39], s[0:1], 64
    s_load_dwordx4 s[40:43], s[0:1], 96
    v_and_b32 v1, 63, v0
    v_lshrrev_b32 v2, 6, v0
    s_nop 0
    v_readfirstlane_b32 s3, v2
    v_and_b32 v3, 31, v1
    v_lshrrev_b32 v4, 5, v1
    s_waitcnt lgkmcnt(0)
    s_mov_b32 s44, s42
    s_mov_b32 s45, s43
    s_mov_b32 s46, 268435456
    s_mov_b32 s47, 0x20000
    s_cmp_lt_u32 s2, 256
    s_cbranch_scc1 L_S1
    s_cmp_lt_u32 s2, 704
    s_cbranch_scc1 L_A
    s_cmp_lt_u32 s2, 718
    s_cbranch_scc1 L_WO
    s_endpgm
L_WO:
    s_mov_b32 s48, s36
    s_mov_b32 s49, s37
    s_mov_b32 s50, 401408
    s_mov_b32 s51, 0x20000
    s_sub_u32 s4, s2, 704
    s_lshl_b32 s5, s3, 2
    s_add_u32 s5, s5, 0
    v_lshlrev_b32 v5, 2, v4
    v_add_u32 v5, 0, v5
    s_mul_i32 s6, s5, 28
    v_add_u32 v6, s6, v5
    v_mul_u32_u24 v6, 896, v6
    s_lshl_b32 s6, s4, 6
    v_add_u32 v6, s6, v6
    v_lshl_add_u32 v6, v3, 1, v6
    v_cmp_gt_u32 vcc, 28, v5
    v_mov_b32 v7, 0x7fffffff
    s_nop 1
    v_cndmask_b32 v6, v7, v6, vcc
    buffer_load_ushort v10, v6, s[48:51], 0 offen
    v_lshlrev_b32 v5, 2, v4
    v_add_u32 v5, 1, v5
    s_mul_i32 s6, s5, 28
    v_add_u32 v6, s6, v5
    v_mul_u32_u24 v6, 896, v6
    s_lshl_b32 s6, s4, 6
    v_add_u32 v6, s6, v6
    v_lshl_add_u32 v6, v3, 1, v6
    v_cmp_gt_u32 vcc, 28, v5
    v_mov_b32 v7, 0x7fffffff
    s_nop 1
    v_cndmask_b32 v6, v7, v6, vcc
    buffer_load_ushort v11, v6, s[48:51], 0 offen
    v_lshlrev_b32 v5, 2, v4
    v_add_u32 v5, 2, v5
    s_mul_i32 s6, s5, 28
    v_add_u32 v6, s6, v5
    v_mul_u32_u24 v6, 896, v6
    s_lshl_b32 s6, s4, 6
    v_add_u32 v6, s6, v6
    v_lshl_add_u32 v6, v3, 1, v6
    v_cmp_gt_u32 vcc, 28, v5
    v_mov_b32 v7, 0x7fffffff
    s_nop 1
    v_cndmask_b32 v6, v7, v6, vcc
    buffer_load_ushort v12, v6, s[48:51], 0 offen
    v_lshlrev_b32 v5, 2, v4
    v_add_u32 v5, 3, v5
    s_mul_i32 s6, s5, 28
    v_add_u32 v6, s6, v5
    v_mul_u32_u24 v6, 896, v6
    s_lshl_b32 s6, s4, 6
    v_add_u32 v6, s6, v6
    v_lshl_add_u32 v6, v3, 1, v6
    v_cmp_gt_u32 vcc, 28, v5
    v_mov_b32 v7, 0x7fffffff
    s_nop 1
    v_cndmask_b32 v6, v7, v6, vcc
    buffer_load_ushort v13, v6, s[48:51], 0 offen
    v_lshlrev_b32 v5, 2, v4
    v_add_u32 v5, 8, v5
    s_mul_i32 s6, s5, 28
    v_add_u32 v6, s6, v5
    v_mul_u32_u24 v6, 896, v6
    s_lshl_b32 s6, s4, 6
    v_add_u32 v6, s6, v6
    v_lshl_add_u32 v6, v3, 1, v6
    v_cmp_gt_u32 vcc, 28, v5
    v_mov_b32 v7, 0x7fffffff
    s_nop 1
    v_cndmask_b32 v6, v7, v6, vcc
    buffer_load_ushort v14, v6, s[48:51], 0 offen
    v_lshlrev_b32 v5, 2, v4
    v_add_u32 v5, 9, v5
    s_mul_i32 s6, s5, 28
    v_add_u32 v6, s6, v5
    v_mul_u32_u24 v6, 896, v6
    s_lshl_b32 s6, s4, 6
    v_add_u32 v6, s6, v6
    v_lshl_add_u32 v6, v3, 1, v6
    v_cmp_gt_u32 vcc, 28, v5
    v_mov_b32 v7, 0x7fffffff
    s_nop 1
    v_cndmask_b32 v6, v7, v6, vcc
    buffer_load_ushort v15, v6, s[48:51], 0 offen
    v_lshlrev_b32 v5, 2, v4
    v_add_u32 v5, 10, v5
    s_mul_i32 s6, s5, 28
    v_add_u32 v6, s6, v5
    v_mul_u32_u24 v6, 896, v6
    s_lshl_b32 s6, s4, 6
    v_add_u32 v6, s6, v6
    v_lshl_add_u32 v6, v3, 1, v6
    v_cmp_gt_u32 vcc, 28, v5
    v_mov_b32 v7, 0x7fffffff
    s_nop 1
    v_cndmask_b32 v6, v7, v6, vcc
    buffer_load_ushort v16, v6, s[48:51], 0 offen
    v_lshlrev_b32 v5, 2, v4
    v_add_u32 v5, 11, v5
    s_mul_i32 s6, s5, 28
    v_add_u32 v6, s6, v5
    v_mul_u32_u24 v6, 896, v6
    s_lshl_b32 s6, s4, 6
    v_add_u32 v6, s6, v6
    v_lshl_add_u32 v6, v3, 1, v6
    v_cmp_gt_u32 vcc, 28, v5
    v_mov_b32 v7, 0x7fffffff
    s_nop 1
    v_cndmask_b32 v6, v7, v6, vcc
    buffer_load_ushort v17, v6, s[48:51], 0 offen
    s_waitcnt vmcnt(0)
    v_lshl_or_b32 v20, v11, 16, v10
    v_lshl_or_b32 v21, v13, 16, v12
    v_lshl_or_b32 v22, v15, 16, v14
    v_lshl_or_b32 v23, v17, 16, v16
    s_lshl_b32 s6, s4, 5
    s_lshl_b32 s7, s5, 1
    s_add_u32 s6, s6, s7
    s_add_u32 s6, s6, 0
    s_lshl_b32 s6, s6, 10
    s_add_u32 s6, s6, 8388608
    v_lshlrev_b32 v6, 4, v1
    buffer_store_dwordx4 v[20:23], v6, s[44:47], s6 offen
    s_nop 2
    s_lshl_b32 s5, s3, 2
    s_add_u32 s5, s5, 0
    v_lshlrev_b32 v5, 2, v4
    v_add_u32 v5, 16, v5
    s_mul_i32 s6, s5, 28
    v_add_u32 v6, s6, v5
    v_mul_u32_u24 v6, 896, v6
    s_lshl_b32 s6, s4, 6
    v_add_u32 v6, s6, v6
    v_lshl_add_u32 v6, v3, 1, v6
    v_cmp_gt_u32 vcc, 28, v5
    v_mov_b32 v7, 0x7fffffff
    s_nop 1
    v_cndmask_b32 v6, v7, v6, vcc
    buffer_load_ushort v10, v6, s[48:51], 0 offen
    v_lshlrev_b32 v5, 2, v4
    v_add_u32 v5, 17, v5
    s_mul_i32 s6, s5, 28
    v_add_u32 v6, s6, v5
    v_mul_u32_u24 v6, 896, v6
    s_lshl_b32 s6, s4, 6
    v_add_u32 v6, s6, v6
    v_lshl_add_u32 v6, v3, 1, v6
    v_cmp_gt_u32 vcc, 28, v5
    v_mov_b32 v7, 0x7fffffff
    s_nop 1
    v_cndmask_b32 v6, v7, v6, vcc
    buffer_load_ushort v11, v6, s[48:51], 0 offen
    v_lshlrev_b32 v5, 2, v4
    v_add_u32 v5, 18, v5
    s_mul_i32 s6, s5, 28
    v_add_u32 v6, s6, v5
    v_mul_u32_u24 v6, 896, v6
    s_lshl_b32 s6, s4, 6
    v_add_u32 v6, s6, v6
    v_lshl_add_u32 v6, v3, 1, v6
    v_cmp_gt_u32 vcc, 28, v5
    v_mov_b32 v7, 0x7fffffff
    s_nop 1
    v_cndmask_b32 v6, v7, v6, vcc
    buffer_load_ushort v12, v6, s[48:51], 0 offen
    v_lshlrev_b32 v5, 2, v4
    v_add_u32 v5, 19, v5
    s_mul_i32 s6, s5, 28
    v_add_u32 v6, s6, v5
    v_mul_u32_u24 v6, 896, v6
    s_lshl_b32 s6, s4, 6
    v_add_u32 v6, s6, v6
    v_lshl_add_u32 v6, v3, 1, v6
    v_cmp_gt_u32 vcc, 28, v5
    v_mov_b32 v7, 0x7fffffff
    s_nop 1
    v_cndmask_b32 v6, v7, v6, vcc
    buffer_load_ushort v13, v6, s[48:51], 0 offen
    v_lshlrev_b32 v5, 2, v4
    v_add_u32 v5, 24, v5
    s_mul_i32 s6, s5, 28
    v_add_u32 v6, s6, v5
    v_mul_u32_u24 v6, 896, v6
    s_lshl_b32 s6, s4, 6
    v_add_u32 v6, s6, v6
    v_lshl_add_u32 v6, v3, 1, v6
    v_cmp_gt_u32 vcc, 28, v5
    v_mov_b32 v7, 0x7fffffff
    s_nop 1
    v_cndmask_b32 v6, v7, v6, vcc
    buffer_load_ushort v14, v6, s[48:51], 0 offen
    v_lshlrev_b32 v5, 2, v4
    v_add_u32 v5, 25, v5
    s_mul_i32 s6, s5, 28
    v_add_u32 v6, s6, v5
    v_mul_u32_u24 v6, 896, v6
    s_lshl_b32 s6, s4, 6
    v_add_u32 v6, s6, v6
    v_lshl_add_u32 v6, v3, 1, v6
    v_cmp_gt_u32 vcc, 28, v5
    v_mov_b32 v7, 0x7fffffff
    s_nop 1
    v_cndmask_b32 v6, v7, v6, vcc
    buffer_load_ushort v15, v6, s[48:51], 0 offen
    v_lshlrev_b32 v5, 2, v4
    v_add_u32 v5, 26, v5
    s_mul_i32 s6, s5, 28
    v_add_u32 v6, s6, v5
    v_mul_u32_u24 v6, 896, v6
    s_lshl_b32 s6, s4, 6
    v_add_u32 v6, s6, v6
    v_lshl_add_u32 v6, v3, 1, v6
    v_cmp_gt_u32 vcc, 28, v5
    v_mov_b32 v7, 0x7fffffff
    s_nop 1
    v_cndmask_b32 v6, v7, v6, vcc
    buffer_load_ushort v16, v6, s[48:51], 0 offen
    v_lshlrev_b32 v5, 2, v4
    v_add_u32 v5, 27, v5
    s_mul_i32 s6, s5, 28
    v_add_u32 v6, s6, v5
    v_mul_u32_u24 v6, 896, v6
    s_lshl_b32 s6, s4, 6
    v_add_u32 v6, s6, v6
    v_lshl_add_u32 v6, v3, 1, v6
    v_cmp_gt_u32 vcc, 28, v5
    v_mov_b32 v7, 0x7fffffff
    s_nop 1
    v_cndmask_b32 v6, v7, v6, vcc
    buffer_load_ushort v17, v6, s[48:51], 0 offen
    s_waitcnt vmcnt(0)
    v_lshl_or_b32 v20, v11, 16, v10
    v_lshl_or_b32 v21, v13, 16, v12
    v_lshl_or_b32 v22, v15, 16, v14
    v_lshl_or_b32 v23, v17, 16, v16
    s_lshl_b32 s6, s4, 5
    s_lshl_b32 s7, s5, 1
    s_add_u32 s6, s6, s7
    s_add_u32 s6, s6, 1
    s_lshl_b32 s6, s6, 10
    s_add_u32 s6, s6, 8388608
    v_lshlrev_b32 v6, 4, v1
    buffer_store_dwordx4 v[20:23], v6, s[44:47], s6 offen
    s_nop 2
    s_lshl_b32 s5, s3, 2
    s_add_u32 s5, s5, 1
    v_lshlrev_b32 v5, 2, v4
    v_add_u32 v5, 0, v5
    s_mul_i32 s6, s5, 28
    v_add_u32 v6, s6, v5
    v_mul_u32_u24 v6, 896, v6
    s_lshl_b32 s6, s4, 6
    v_add_u32 v6, s6, v6
    v_lshl_add_u32 v6, v3, 1, v6
    v_cmp_gt_u32 vcc, 28, v5
    v_mov_b32 v7, 0x7fffffff
    s_nop 1
    v_cndmask_b32 v6, v7, v6, vcc
    buffer_load_ushort v10, v6, s[48:51], 0 offen
    v_lshlrev_b32 v5, 2, v4
    v_add_u32 v5, 1, v5
    s_mul_i32 s6, s5, 28
    v_add_u32 v6, s6, v5
    v_mul_u32_u24 v6, 896, v6
    s_lshl_b32 s6, s4, 6
    v_add_u32 v6, s6, v6
    v_lshl_add_u32 v6, v3, 1, v6
    v_cmp_gt_u32 vcc, 28, v5
    v_mov_b32 v7, 0x7fffffff
    s_nop 1
    v_cndmask_b32 v6, v7, v6, vcc
    buffer_load_ushort v11, v6, s[48:51], 0 offen
    v_lshlrev_b32 v5, 2, v4
    v_add_u32 v5, 2, v5
    s_mul_i32 s6, s5, 28
    v_add_u32 v6, s6, v5
    v_mul_u32_u24 v6, 896, v6
    s_lshl_b32 s6, s4, 6
    v_add_u32 v6, s6, v6
    v_lshl_add_u32 v6, v3, 1, v6
    v_cmp_gt_u32 vcc, 28, v5
    v_mov_b32 v7, 0x7fffffff
    s_nop 1
    v_cndmask_b32 v6, v7, v6, vcc
    buffer_load_ushort v12, v6, s[48:51], 0 offen
    v_lshlrev_b32 v5, 2, v4
    v_add_u32 v5, 3, v5
    s_mul_i32 s6, s5, 28
    v_add_u32 v6, s6, v5
    v_mul_u32_u24 v6, 896, v6
    s_lshl_b32 s6, s4, 6
    v_add_u32 v6, s6, v6
    v_lshl_add_u32 v6, v3, 1, v6
    v_cmp_gt_u32 vcc, 28, v5
    v_mov_b32 v7, 0x7fffffff
    s_nop 1
    v_cndmask_b32 v6, v7, v6, vcc
    buffer_load_ushort v13, v6, s[48:51], 0 offen
    v_lshlrev_b32 v5, 2, v4
    v_add_u32 v5, 8, v5
    s_mul_i32 s6, s5, 28
    v_add_u32 v6, s6, v5
    v_mul_u32_u24 v6, 896, v6
    s_lshl_b32 s6, s4, 6
    v_add_u32 v6, s6, v6
    v_lshl_add_u32 v6, v3, 1, v6
    v_cmp_gt_u32 vcc, 28, v5
    v_mov_b32 v7, 0x7fffffff
    s_nop 1
    v_cndmask_b32 v6, v7, v6, vcc
    buffer_load_ushort v14, v6, s[48:51], 0 offen
    v_lshlrev_b32 v5, 2, v4
    v_add_u32 v5, 9, v5
    s_mul_i32 s6, s5, 28
    v_add_u32 v6, s6, v5
    v_mul_u32_u24 v6, 896, v6
    s_lshl_b32 s6, s4, 6
    v_add_u32 v6, s6, v6
    v_lshl_add_u32 v6, v3, 1, v6
    v_cmp_gt_u32 vcc, 28, v5
    v_mov_b32 v7, 0x7fffffff
    s_nop 1
    v_cndmask_b32 v6, v7, v6, vcc
    buffer_load_ushort v15, v6, s[48:51], 0 offen
    v_lshlrev_b32 v5, 2, v4
    v_add_u32 v5, 10, v5
    s_mul_i32 s6, s5, 28
    v_add_u32 v6, s6, v5
    v_mul_u32_u24 v6, 896, v6
    s_lshl_b32 s6, s4, 6
    v_add_u32 v6, s6, v6
    v_lshl_add_u32 v6, v3, 1, v6
    v_cmp_gt_u32 vcc, 28, v5
    v_mov_b32 v7, 0x7fffffff
    s_nop 1
    v_cndmask_b32 v6, v7, v6, vcc
    buffer_load_ushort v16, v6, s[48:51], 0 offen
    v_lshlrev_b32 v5, 2, v4
    v_add_u32 v5, 11, v5
    s_mul_i32 s6, s5, 28
    v_add_u32 v6, s6, v5
    v_mul_u32_u24 v6, 896, v6
    s_lshl_b32 s6, s4, 6
    v_add_u32 v6, s6, v6
    v_lshl_add_u32 v6, v3, 1, v6
    v_cmp_gt_u32 vcc, 28, v5
    v_mov_b32 v7, 0x7fffffff
    s_nop 1
    v_cndmask_b32 v6, v7, v6, vcc
    buffer_load_ushort v17, v6, s[48:51], 0 offen
    s_waitcnt vmcnt(0)
    v_lshl_or_b32 v20, v11, 16, v10
    v_lshl_or_b32 v21, v13, 16, v12
    v_lshl_or_b32 v22, v15, 16, v14
    v_lshl_or_b32 v23, v17, 16, v16
    s_lshl_b32 s6, s4, 5
    s_lshl_b32 s7, s5, 1
    s_add_u32 s6, s6, s7
    s_add_u32 s6, s6, 0
    s_lshl_b32 s6, s6, 10
    s_add_u32 s6, s6, 8388608
    v_lshlrev_b32 v6, 4, v1
    buffer_store_dwordx4 v[20:23], v6, s[44:47], s6 offen
    s_nop 2
    s_lshl_b32 s5, s3, 2
    s_add_u32 s5, s5, 1
    v_lshlrev_b32 v5, 2, v4
    v_add_u32 v5, 16, v5
    s_mul_i32 s6, s5, 28
    v_add_u32 v6, s6, v5
    v_mul_u32_u24 v6, 896, v6
    s_lshl_b32 s6, s4, 6
    v_add_u32 v6, s6, v6
    v_lshl_add_u32 v6, v3, 1, v6
    v_cmp_gt_u32 vcc, 28, v5
    v_mov_b32 v7, 0x7fffffff
    s_nop 1
    v_cndmask_b32 v6, v7, v6, vcc
    buffer_load_ushort v10, v6, s[48:51], 0 offen
    v_lshlrev_b32 v5, 2, v4
    v_add_u32 v5, 17, v5
    s_mul_i32 s6, s5, 28
    v_add_u32 v6, s6, v5
    v_mul_u32_u24 v6, 896, v6
    s_lshl_b32 s6, s4, 6
    v_add_u32 v6, s6, v6
    v_lshl_add_u32 v6, v3, 1, v6
    v_cmp_gt_u32 vcc, 28, v5
    v_mov_b32 v7, 0x7fffffff
    s_nop 1
    v_cndmask_b32 v6, v7, v6, vcc
    buffer_load_ushort v11, v6, s[48:51], 0 offen
    v_lshlrev_b32 v5, 2, v4
    v_add_u32 v5, 18, v5
    s_mul_i32 s6, s5, 28
    v_add_u32 v6, s6, v5
    v_mul_u32_u24 v6, 896, v6
    s_lshl_b32 s6, s4, 6
    v_add_u32 v6, s6, v6
    v_lshl_add_u32 v6, v3, 1, v6
    v_cmp_gt_u32 vcc, 28, v5
    v_mov_b32 v7, 0x7fffffff
    s_nop 1
    v_cndmask_b32 v6, v7, v6, vcc
    buffer_load_ushort v12, v6, s[48:51], 0 offen
    v_lshlrev_b32 v5, 2, v4
    v_add_u32 v5, 19, v5
    s_mul_i32 s6, s5, 28
    v_add_u32 v6, s6, v5
    v_mul_u32_u24 v6, 896, v6
    s_lshl_b32 s6, s4, 6
    v_add_u32 v6, s6, v6
    v_lshl_add_u32 v6, v3, 1, v6
    v_cmp_gt_u32 vcc, 28, v5
    v_mov_b32 v7, 0x7fffffff
    s_nop 1
    v_cndmask_b32 v6, v7, v6, vcc
    buffer_load_ushort v13, v6, s[48:51], 0 offen
    v_lshlrev_b32 v5, 2, v4
    v_add_u32 v5, 24, v5
    s_mul_i32 s6, s5, 28
    v_add_u32 v6, s6, v5
    v_mul_u32_u24 v6, 896, v6
    s_lshl_b32 s6, s4, 6
    v_add_u32 v6, s6, v6
    v_lshl_add_u32 v6, v3, 1, v6
    v_cmp_gt_u32 vcc, 28, v5
    v_mov_b32 v7, 0x7fffffff
    s_nop 1
    v_cndmask_b32 v6, v7, v6, vcc
    buffer_load_ushort v14, v6, s[48:51], 0 offen
    v_lshlrev_b32 v5, 2, v4
    v_add_u32 v5, 25, v5
    s_mul_i32 s6, s5, 28
    v_add_u32 v6, s6, v5
    v_mul_u32_u24 v6, 896, v6
    s_lshl_b32 s6, s4, 6
    v_add_u32 v6, s6, v6
    v_lshl_add_u32 v6, v3, 1, v6
    v_cmp_gt_u32 vcc, 28, v5
    v_mov_b32 v7, 0x7fffffff
    s_nop 1
    v_cndmask_b32 v6, v7, v6, vcc
    buffer_load_ushort v15, v6, s[48:51], 0 offen
    v_lshlrev_b32 v5, 2, v4
    v_add_u32 v5, 26, v5
    s_mul_i32 s6, s5, 28
    v_add_u32 v6, s6, v5
    v_mul_u32_u24 v6, 896, v6
    s_lshl_b32 s6, s4, 6
    v_add_u32 v6, s6, v6
    v_lshl_add_u32 v6, v3, 1, v6
    v_cmp_gt_u32 vcc, 28, v5
    v_mov_b32 v7, 0x7fffffff
    s_nop 1
    v_cndmask_b32 v6, v7, v6, vcc
    buffer_load_ushort v16, v6, s[48:51], 0 offen
    v_lshlrev_b32 v5, 2, v4
    v_add_u32 v5, 27, v5
    s_mul_i32 s6, s5, 28
    v_add_u32 v6, s6, v5
    v_mul_u32_u24 v6, 896, v6
    s_lshl_b32 s6, s4, 6
    v_add_u32 v6, s6, v6
    v_lshl_add_u32 v6, v3, 1, v6
    v_cmp_gt_u32 vcc, 28, v5
    v_mov_b32 v7, 0x7fffffff
    s_nop 1
    v_cndmask_b32 v6, v7, v6, vcc
    buffer_load_ushort v17, v6, s[48:51], 0 offen
    s_waitcnt vmcnt(0)
    v_lshl_or_b32 v20, v11, 16, v10
    v_lshl_or_b32 v21, v13, 16, v12
    v_lshl_or_b32 v22, v15, 16, v14
    v_lshl_or_b32 v23, v17, 16, v16
    s_lshl_b32 s6, s4, 5
    s_lshl_b32 s7, s5, 1
    s_add_u32 s6, s6, s7
    s_add_u32 s6, s6, 1
    s_lshl_b32 s6, s6, 10
    s_add_u32 s6, s6, 8388608
    v_lshlrev_b32 v6, 4, v1
    buffer_store_dwordx4 v[20:23], v6, s[44:47], s6 offen
    s_nop 2
    s_lshl_b32 s5, s3, 2
    s_add_u32 s5, s5, 2
    v_lshlrev_b32 v5, 2, v4
    v_add_u32 v5, 0, v5
    s_mul_i32 s6, s5, 28
    v_add_u32 v6, s6, v5
    v_mul_u32_u24 v6, 896, v6
    s_lshl_b32 s6, s4, 6
    v_add_u32 v6, s6, v6
    v_lshl_add_u32 v6, v3, 1, v6
    v_cmp_gt_u32 vcc, 28, v5
    v_mov_b32 v7, 0x7fffffff
    s_nop 1
    v_cndmask_b32 v6, v7, v6, vcc
    buffer_load_ushort v10, v6, s[48:51], 0 offen
    v_lshlrev_b32 v5, 2, v4
    v_add_u32 v5, 1, v5
    s_mul_i32 s6, s5, 28
    v_add_u32 v6, s6, v5
    v_mul_u32_u24 v6, 896, v6
    s_lshl_b32 s6, s4, 6
    v_add_u32 v6, s6, v6
    v_lshl_add_u32 v6, v3, 1, v6
    v_cmp_gt_u32 vcc, 28, v5
    v_mov_b32 v7, 0x7fffffff
    s_nop 1
    v_cndmask_b32 v6, v7, v6, vcc
    buffer_load_ushort v11, v6, s[48:51], 0 offen
    v_lshlrev_b32 v5, 2, v4
    v_add_u32 v5, 2, v5
    s_mul_i32 s6, s5, 28
    v_add_u32 v6, s6, v5
    v_mul_u32_u24 v6, 896, v6
    s_lshl_b32 s6, s4, 6
    v_add_u32 v6, s6, v6
    v_lshl_add_u32 v6, v3, 1, v6
    v_cmp_gt_u32 vcc, 28, v5
    v_mov_b32 v7, 0x7fffffff
    s_nop 1
    v_cndmask_b32 v6, v7, v6, vcc
    buffer_load_ushort v12, v6, s[48:51], 0 offen
    v_lshlrev_b32 v5, 2, v4
    v_add_u32 v5, 3, v5
    s_mul_i32 s6, s5, 28
    v_add_u32 v6, s6, v5
    v_mul_u32_u24 v6, 896, v6
    s_lshl_b32 s6, s4, 6
    v_add_u32 v6, s6, v6
    v_lshl_add_u32 v6, v3, 1, v6
    v_cmp_gt_u32 vcc, 28, v5
    v_mov_b32 v7, 0x7fffffff
    s_nop 1
    v_cndmask_b32 v6, v7, v6, vcc
    buffer_load_ushort v13, v6, s[48:51], 0 offen
    v_lshlrev_b32 v5, 2, v4
    v_add_u32 v5, 8, v5
    s_mul_i32 s6, s5, 28
    v_add_u32 v6, s6, v5
    v_mul_u32_u24 v6, 896, v6
    s_lshl_b32 s6, s4, 6
    v_add_u32 v6, s6, v6
    v_lshl_add_u32 v6, v3, 1, v6
    v_cmp_gt_u32 vcc, 28, v5
    v_mov_b32 v7, 0x7fffffff
    s_nop 1
    v_cndmask_b32 v6, v7, v6, vcc
    buffer_load_ushort v14, v6, s[48:51], 0 offen
    v_lshlrev_b32 v5, 2, v4
    v_add_u32 v5, 9, v5
    s_mul_i32 s6, s5, 28
    v_add_u32 v6, s6, v5
    v_mul_u32_u24 v6, 896, v6
    s_lshl_b32 s6, s4, 6
    v_add_u32 v6, s6, v6
    v_lshl_add_u32 v6, v3, 1, v6
    v_cmp_gt_u32 vcc, 28, v5
    v_mov_b32 v7, 0x7fffffff
    s_nop 1
    v_cndmask_b32 v6, v7, v6, vcc
    buffer_load_ushort v15, v6, s[48:51], 0 offen
    v_lshlrev_b32 v5, 2, v4
    v_add_u32 v5, 10, v5
    s_mul_i32 s6, s5, 28
    v_add_u32 v6, s6, v5
    v_mul_u32_u24 v6, 896, v6
    s_lshl_b32 s6, s4, 6
    v_add_u32 v6, s6, v6
    v_lshl_add_u32 v6, v3, 1, v6
    v_cmp_gt_u32 vcc, 28, v5
    v_mov_b32 v7, 0x7fffffff
    s_nop 1
    v_cndmask_b32 v6, v7, v6, vcc
    buffer_load_ushort v16, v6, s[48:51], 0 offen
    v_lshlrev_b32 v5, 2, v4
    v_add_u32 v5, 11, v5
    s_mul_i32 s6, s5, 28
    v_add_u32 v6, s6, v5
    v_mul_u32_u24 v6, 896, v6
    s_lshl_b32 s6, s4, 6
    v_add_u32 v6, s6, v6
    v_lshl_add_u32 v6, v3, 1, v6
    v_cmp_gt_u32 vcc, 28, v5
    v_mov_b32 v7, 0x7fffffff
    s_nop 1
    v_cndmask_b32 v6, v7, v6, vcc
    buffer_load_ushort v17, v6, s[48:51], 0 offen
    s_waitcnt vmcnt(0)
    v_lshl_or_b32 v20, v11, 16, v10
    v_lshl_or_b32 v21, v13, 16, v12
    v_lshl_or_b32 v22, v15, 16, v14
    v_lshl_or_b32 v23, v17, 16, v16
    s_lshl_b32 s6, s4, 5
    s_lshl_b32 s7, s5, 1
    s_add_u32 s6, s6, s7
    s_add_u32 s6, s6, 0
    s_lshl_b32 s6, s6, 10
    s_add_u32 s6, s6, 8388608
    v_lshlrev_b32 v6, 4, v1
    buffer_store_dwordx4 v[20:23], v6, s[44:47], s6 offen
    s_nop 2
    s_lshl_b32 s5, s3, 2
    s_add_u32 s5, s5, 2
    v_lshlrev_b32 v5, 2, v4
    v_add_u32 v5, 16, v5
    s_mul_i32 s6, s5, 28
    v_add_u32 v6, s6, v5
    v_mul_u32_u24 v6, 896, v6
    s_lshl_b32 s6, s4, 6
    v_add_u32 v6, s6, v6
    v_lshl_add_u32 v6, v3, 1, v6
    v_cmp_gt_u32 vcc, 28, v5
    v_mov_b32 v7, 0x7fffffff
    s_nop 1
    v_cndmask_b32 v6, v7, v6, vcc
    buffer_load_ushort v10, v6, s[48:51], 0 offen
    v_lshlrev_b32 v5, 2, v4
    v_add_u32 v5, 17, v5
    s_mul_i32 s6, s5, 28
    v_add_u32 v6, s6, v5
    v_mul_u32_u24 v6, 896, v6
    s_lshl_b32 s6, s4, 6
    v_add_u32 v6, s6, v6
    v_lshl_add_u32 v6, v3, 1, v6
    v_cmp_gt_u32 vcc, 28, v5
    v_mov_b32 v7, 0x7fffffff
    s_nop 1
    v_cndmask_b32 v6, v7, v6, vcc
    buffer_load_ushort v11, v6, s[48:51], 0 offen
    v_lshlrev_b32 v5, 2, v4
    v_add_u32 v5, 18, v5
    s_mul_i32 s6, s5, 28
    v_add_u32 v6, s6, v5
    v_mul_u32_u24 v6, 896, v6
    s_lshl_b32 s6, s4, 6
    v_add_u32 v6, s6, v6
    v_lshl_add_u32 v6, v3, 1, v6
    v_cmp_gt_u32 vcc, 28, v5
    v_mov_b32 v7, 0x7fffffff
    s_nop 1
    v_cndmask_b32 v6, v7, v6, vcc
    buffer_load_ushort v12, v6, s[48:51], 0 offen
    v_lshlrev_b32 v5, 2, v4
    v_add_u32 v5, 19, v5
    s_mul_i32 s6, s5, 28
    v_add_u32 v6, s6, v5
    v_mul_u32_u24 v6, 896, v6
    s_lshl_b32 s6, s4, 6
    v_add_u32 v6, s6, v6
    v_lshl_add_u32 v6, v3, 1, v6
    v_cmp_gt_u32 vcc, 28, v5
    v_mov_b32 v7, 0x7fffffff
    s_nop 1
    v_cndmask_b32 v6, v7, v6, vcc
    buffer_load_ushort v13, v6, s[48:51], 0 offen
    v_lshlrev_b32 v5, 2, v4
    v_add_u32 v5, 24, v5
    s_mul_i32 s6, s5, 28
    v_add_u32 v6, s6, v5
    v_mul_u32_u24 v6, 896, v6
    s_lshl_b32 s6, s4, 6
    v_add_u32 v6, s6, v6
    v_lshl_add_u32 v6, v3, 1, v6
    v_cmp_gt_u32 vcc, 28, v5
    v_mov_b32 v7, 0x7fffffff
    s_nop 1
    v_cndmask_b32 v6, v7, v6, vcc
    buffer_load_ushort v14, v6, s[48:51], 0 offen
    v_lshlrev_b32 v5, 2, v4
    v_add_u32 v5, 25, v5
    s_mul_i32 s6, s5, 28
    v_add_u32 v6, s6, v5
    v_mul_u32_u24 v6, 896, v6
    s_lshl_b32 s6, s4, 6
    v_add_u32 v6, s6, v6
    v_lshl_add_u32 v6, v3, 1, v6
    v_cmp_gt_u32 vcc, 28, v5
    v_mov_b32 v7, 0x7fffffff
    s_nop 1
    v_cndmask_b32 v6, v7, v6, vcc
    buffer_load_ushort v15, v6, s[48:51], 0 offen
    v_lshlrev_b32 v5, 2, v4
    v_add_u32 v5, 26, v5
    s_mul_i32 s6, s5, 28
    v_add_u32 v6, s6, v5
    v_mul_u32_u24 v6, 896, v6
    s_lshl_b32 s6, s4, 6
    v_add_u32 v6, s6, v6
    v_lshl_add_u32 v6, v3, 1, v6
    v_cmp_gt_u32 vcc, 28, v5
    v_mov_b32 v7, 0x7fffffff
    s_nop 1
    v_cndmask_b32 v6, v7, v6, vcc
    buffer_load_ushort v16, v6, s[48:51], 0 offen
    v_lshlrev_b32 v5, 2, v4
    v_add_u32 v5, 27, v5
    s_mul_i32 s6, s5, 28
    v_add_u32 v6, s6, v5
    v_mul_u32_u24 v6, 896, v6
    s_lshl_b32 s6, s4, 6
    v_add_u32 v6, s6, v6
    v_lshl_add_u32 v6, v3, 1, v6
    v_cmp_gt_u32 vcc, 28, v5
    v_mov_b32 v7, 0x7fffffff
    s_nop 1
    v_cndmask_b32 v6, v7, v6, vcc
    buffer_load_ushort v17, v6, s[48:51], 0 offen
    s_waitcnt vmcnt(0)
    v_lshl_or_b32 v20, v11, 16, v10
    v_lshl_or_b32 v21, v13, 16, v12
    v_lshl_or_b32 v22, v15, 16, v14
    v_lshl_or_b32 v23, v17, 16, v16
    s_lshl_b32 s6, s4, 5
    s_lshl_b32 s7, s5, 1
    s_add_u32 s6, s6, s7
    s_add_u32 s6, s6, 1
    s_lshl_b32 s6, s6, 10
    s_add_u32 s6, s6, 8388608
    v_lshlrev_b32 v6, 4, v1
    buffer_store_dwordx4 v[20:23], v6, s[44:47], s6 offen
    s_nop 2
    s_lshl_b32 s5, s3, 2
    s_add_u32 s5, s5, 3
    v_lshlrev_b32 v5, 2, v4
    v_add_u32 v5, 0, v5
    s_mul_i32 s6, s5, 28
    v_add_u32 v6, s6, v5
    v_mul_u32_u24 v6, 896, v6
    s_lshl_b32 s6, s4, 6
    v_add_u32 v6, s6, v6
    v_lshl_add_u32 v6, v3, 1, v6
    v_cmp_gt_u32 vcc, 28, v5
    v_mov_b32 v7, 0x7fffffff
    s_nop 1
    v_cndmask_b32 v6, v7, v6, vcc
    buffer_load_ushort v10, v6, s[48:51], 0 offen
    v_lshlrev_b32 v5, 2, v4
    v_add_u32 v5, 1, v5
    s_mul_i32 s6, s5, 28
    v_add_u32 v6, s6, v5
    v_mul_u32_u24 v6, 896, v6
    s_lshl_b32 s6, s4, 6
    v_add_u32 v6, s6, v6
    v_lshl_add_u32 v6, v3, 1, v6
    v_cmp_gt_u32 vcc, 28, v5
    v_mov_b32 v7, 0x7fffffff
    s_nop 1
    v_cndmask_b32 v6, v7, v6, vcc
    buffer_load_ushort v11, v6, s[48:51], 0 offen
    v_lshlrev_b32 v5, 2, v4
    v_add_u32 v5, 2, v5
    s_mul_i32 s6, s5, 28
    v_add_u32 v6, s6, v5
    v_mul_u32_u24 v6, 896, v6
    s_lshl_b32 s6, s4, 6
    v_add_u32 v6, s6, v6
    v_lshl_add_u32 v6, v3, 1, v6
    v_cmp_gt_u32 vcc, 28, v5
    v_mov_b32 v7, 0x7fffffff
    s_nop 1
    v_cndmask_b32 v6, v7, v6, vcc
    buffer_load_ushort v12, v6, s[48:51], 0 offen
    v_lshlrev_b32 v5, 2, v4
    v_add_u32 v5, 3, v5
    s_mul_i32 s6, s5, 28
    v_add_u32 v6, s6, v5
    v_mul_u32_u24 v6, 896, v6
    s_lshl_b32 s6, s4, 6
    v_add_u32 v6, s6, v6
    v_lshl_add_u32 v6, v3, 1, v6
    v_cmp_gt_u32 vcc, 28, v5
    v_mov_b32 v7, 0x7fffffff
    s_nop 1
    v_cndmask_b32 v6, v7, v6, vcc
    buffer_load_ushort v13, v6, s[48:51], 0 offen
    v_lshlrev_b32 v5, 2, v4
    v_add_u32 v5, 8, v5
    s_mul_i32 s6, s5, 28
    v_add_u32 v6, s6, v5
    v_mul_u32_u24 v6, 896, v6
    s_lshl_b32 s6, s4, 6
    v_add_u32 v6, s6, v6
    v_lshl_add_u32 v6, v3, 1, v6
    v_cmp_gt_u32 vcc, 28, v5
    v_mov_b32 v7, 0x7fffffff
    s_nop 1
    v_cndmask_b32 v6, v7, v6, vcc
    buffer_load_ushort v14, v6, s[48:51], 0 offen
    v_lshlrev_b32 v5, 2, v4
    v_add_u32 v5, 9, v5
    s_mul_i32 s6, s5, 28
    v_add_u32 v6, s6, v5
    v_mul_u32_u24 v6, 896, v6
    s_lshl_b32 s6, s4, 6
    v_add_u32 v6, s6, v6
    v_lshl_add_u32 v6, v3, 1, v6
    v_cmp_gt_u32 vcc, 28, v5
    v_mov_b32 v7, 0x7fffffff
    s_nop 1
    v_cndmask_b32 v6, v7, v6, vcc
    buffer_load_ushort v15, v6, s[48:51], 0 offen
    v_lshlrev_b32 v5, 2, v4
    v_add_u32 v5, 10, v5
    s_mul_i32 s6, s5, 28
    v_add_u32 v6, s6, v5
    v_mul_u32_u24 v6, 896, v6
    s_lshl_b32 s6, s4, 6
    v_add_u32 v6, s6, v6
    v_lshl_add_u32 v6, v3, 1, v6
    v_cmp_gt_u32 vcc, 28, v5
    v_mov_b32 v7, 0x7fffffff
    s_nop 1
    v_cndmask_b32 v6, v7, v6, vcc
    buffer_load_ushort v16, v6, s[48:51], 0 offen
    v_lshlrev_b32 v5, 2, v4
    v_add_u32 v5, 11, v5
    s_mul_i32 s6, s5, 28
    v_add_u32 v6, s6, v5
    v_mul_u32_u24 v6, 896, v6
    s_lshl_b32 s6, s4, 6
    v_add_u32 v6, s6, v6
    v_lshl_add_u32 v6, v3, 1, v6
    v_cmp_gt_u32 vcc, 28, v5
    v_mov_b32 v7, 0x7fffffff
    s_nop 1
    v_cndmask_b32 v6, v7, v6, vcc
    buffer_load_ushort v17, v6, s[48:51], 0 offen
    s_waitcnt vmcnt(0)
    v_lshl_or_b32 v20, v11, 16, v10
    v_lshl_or_b32 v21, v13, 16, v12
    v_lshl_or_b32 v22, v15, 16, v14
    v_lshl_or_b32 v23, v17, 16, v16
    s_lshl_b32 s6, s4, 5
    s_lshl_b32 s7, s5, 1
    s_add_u32 s6, s6, s7
    s_add_u32 s6, s6, 0
    s_lshl_b32 s6, s6, 10
    s_add_u32 s6, s6, 8388608
    v_lshlrev_b32 v6, 4, v1
    buffer_store_dwordx4 v[20:23], v6, s[44:47], s6 offen
    s_nop 2
    s_lshl_b32 s5, s3, 2
    s_add_u32 s5, s5, 3
    v_lshlrev_b32 v5, 2, v4
    v_add_u32 v5, 16, v5
    s_mul_i32 s6, s5, 28
    v_add_u32 v6, s6, v5
    v_mul_u32_u24 v6, 896, v6
    s_lshl_b32 s6, s4, 6
    v_add_u32 v6, s6, v6
    v_lshl_add_u32 v6, v3, 1, v6
    v_cmp_gt_u32 vcc, 28, v5
    v_mov_b32 v7, 0x7fffffff
    s_nop 1
    v_cndmask_b32 v6, v7, v6, vcc
    buffer_load_ushort v10, v6, s[48:51], 0 offen
    v_lshlrev_b32 v5, 2, v4
    v_add_u32 v5, 17, v5
    s_mul_i32 s6, s5, 28
    v_add_u32 v6, s6, v5
    v_mul_u32_u24 v6, 896, v6
    s_lshl_b32 s6, s4, 6
    v_add_u32 v6, s6, v6
    v_lshl_add_u32 v6, v3, 1, v6
    v_cmp_gt_u32 vcc, 28, v5
    v_mov_b32 v7, 0x7fffffff
    s_nop 1
    v_cndmask_b32 v6, v7, v6, vcc
    buffer_load_ushort v11, v6, s[48:51], 0 offen
    v_lshlrev_b32 v5, 2, v4
    v_add_u32 v5, 18, v5
    s_mul_i32 s6, s5, 28
    v_add_u32 v6, s6, v5
    v_mul_u32_u24 v6, 896, v6
    s_lshl_b32 s6, s4, 6
    v_add_u32 v6, s6, v6
    v_lshl_add_u32 v6, v3, 1, v6
    v_cmp_gt_u32 vcc, 28, v5
    v_mov_b32 v7, 0x7fffffff
    s_nop 1
    v_cndmask_b32 v6, v7, v6, vcc
    buffer_load_ushort v12, v6, s[48:51], 0 offen
    v_lshlrev_b32 v5, 2, v4
    v_add_u32 v5, 19, v5
    s_mul_i32 s6, s5, 28
    v_add_u32 v6, s6, v5
    v_mul_u32_u24 v6, 896, v6
    s_lshl_b32 s6, s4, 6
    v_add_u32 v6, s6, v6
    v_lshl_add_u32 v6, v3, 1, v6
    v_cmp_gt_u32 vcc, 28, v5
    v_mov_b32 v7, 0x7fffffff
    s_nop 1
    v_cndmask_b32 v6, v7, v6, vcc
    buffer_load_ushort v13, v6, s[48:51], 0 offen
    v_lshlrev_b32 v5, 2, v4
    v_add_u32 v5, 24, v5
    s_mul_i32 s6, s5, 28
    v_add_u32 v6, s6, v5
    v_mul_u32_u24 v6, 896, v6
    s_lshl_b32 s6, s4, 6
    v_add_u32 v6, s6, v6
    v_lshl_add_u32 v6, v3, 1, v6
    v_cmp_gt_u32 vcc, 28, v5
    v_mov_b32 v7, 0x7fffffff
    s_nop 1
    v_cndmask_b32 v6, v7, v6, vcc
    buffer_load_ushort v14, v6, s[48:51], 0 offen
    v_lshlrev_b32 v5, 2, v4
    v_add_u32 v5, 25, v5
    s_mul_i32 s6, s5, 28
    v_add_u32 v6, s6, v5
    v_mul_u32_u24 v6, 896, v6
    s_lshl_b32 s6, s4, 6
    v_add_u32 v6, s6, v6
    v_lshl_add_u32 v6, v3, 1, v6
    v_cmp_gt_u32 vcc, 28, v5
    v_mov_b32 v7, 0x7fffffff
    s_nop 1
    v_cndmask_b32 v6, v7, v6, vcc
    buffer_load_ushort v15, v6, s[48:51], 0 offen
    v_lshlrev_b32 v5, 2, v4
    v_add_u32 v5, 26, v5
    s_mul_i32 s6, s5, 28
    v_add_u32 v6, s6, v5
    v_mul_u32_u24 v6, 896, v6
    s_lshl_b32 s6, s4, 6
    v_add_u32 v6, s6, v6
    v_lshl_add_u32 v6, v3, 1, v6
    v_cmp_gt_u32 vcc, 28, v5
    v_mov_b32 v7, 0x7fffffff
    s_nop 1
    v_cndmask_b32 v6, v7, v6, vcc
    buffer_load_ushort v16, v6, s[48:51], 0 offen
    v_lshlrev_b32 v5, 2, v4
    v_add_u32 v5, 27, v5
    s_mul_i32 s6, s5, 28
    v_add_u32 v6, s6, v5
    v_mul_u32_u24 v6, 896, v6
    s_lshl_b32 s6, s4, 6
    v_add_u32 v6, s6, v6
    v_lshl_add_u32 v6, v3, 1, v6
    v_cmp_gt_u32 vcc, 28, v5
    v_mov_b32 v7, 0x7fffffff
    s_nop 1
    v_cndmask_b32 v6, v7, v6, vcc
    buffer_load_ushort v17, v6, s[48:51], 0 offen
    s_waitcnt vmcnt(0)
    v_lshl_or_b32 v20, v11, 16, v10
    v_lshl_or_b32 v21, v13, 16, v12
    v_lshl_or_b32 v22, v15, 16, v14
    v_lshl_or_b32 v23, v17, 16, v16
    s_lshl_b32 s6, s4, 5
    s_lshl_b32 s7, s5, 1
    s_add_u32 s6, s6, s7
    s_add_u32 s6, s6, 1
    s_lshl_b32 s6, s6, 10
    s_add_u32 s6, s6, 8388608
    v_lshlrev_b32 v6, 4, v1
    buffer_store_dwordx4 v[20:23], v6, s[44:47], s6 offen
    s_nop 2
    s_endpgm
L_S1:
    s_and_b32 s4, s2, 15
    s_lshr_b32 s5, s2, 4
    s_mov_b32 s48, s30
    s_mov_b32 s49, s31
    s_mov_b32 s50, 1835008
    s_mov_b32 s51, 0x20000
    s_mov_b32 s52, s32
    s_mov_b32 s53, s33
    s_mov_b32 s54, 1204224
    s_mov_b32 s55, 0x20000
    s_mov_b32 s56, s34
    s_mov_b32 s57, s35
    s_mov_b32 s58, 25088
    s_mov_b32 s59, 0x20000
    s_lshl_b32 s6, s5, 7
    s_lshl_b32 s7, s3, 5
    s_add_u32 s6, s6, s7
    v_add_u32 v5, s6, v3
    v_mul_u32_u24 v5, 896, v5
    v_lshl_add_u32 v5, v4, 4, v5
    buffer_load_dwordx4 v[128:131], v5, s[48:51], 0 offen offset:0
    buffer_load_dwordx4 v[132:135], v5, s[48:51], 0 offen offset:32
    buffer_load_dwordx4 v[136:139], v5, s[48:51], 0 offen offset:64
    buffer_load_dwordx4 v[140:143], v5, s[48:51], 0 offen offset:96
    buffer_load_dwordx4 v[144:147], v5, s[48:51], 0 offen offset:128
    buffer_load_dwordx4 v[148:151], v5, s[48:51], 0 offen offset:160
    buffer_load_dwordx4 v[152:155], v5, s[48:51], 0 offen offset:192
    buffer_load_dwordx4 v[156:159], v5, s[48:51], 0 offen offset:224
    buffer_load_dwordx4 v[160:163], v5, s[48:51], 0 offen offset:256
    buffer_load_dwordx4 v[164:167], v5, s[48:51], 0 offen offset:288
    buffer_load_dwordx4 v[168:171], v5, s[48:51], 0 offen offset:320
    buffer_load_dwordx4 v[172:175], v5, s[48:51], 0 offen offset:352
    buffer_load_dwordx4 v[176:179], v5, s[48:51], 0 offen offset:384
    buffer_load_dwordx4 v[180:183], v5, s[48:51], 0 offen offset:416
    buffer_load_dwordx4 v[184:187], v5, s[48:51], 0 offen offset:448
    buffer_load_dwordx4 v[188:191], v5, s[48:51], 0 offen offset:480
    buffer_load_dwordx4 v[192:195], v5, s[48:51], 0 offen offset:512
    buffer_load_dwordx4 v[196:199], v5, s[48:51], 0 offen offset:544
    buffer_load_dwordx4 v[200:203], v5, s[48:51], 0 offen offset:576
    buffer_load_dwordx4 v[204:207], v5, s[48:51], 0 offen offset:608
    buffer_load_dwordx4 v[208:211], v5, s[48:51], 0 offen offset:640
    buffer_load_dwordx4 v[212:215], v5, s[48:51], 0 offen offset:672
    buffer_load_dwordx4 v[216:219], v5, s[48:51], 0 offen offset:704
    buffer_load_dwordx4 v[220:223], v5, s[48:51], 0 offen offset:736
    buffer_load_dwordx4 v[224:227], v5, s[48:51], 0 offen offset:768
    buffer_load_dwordx4 v[228:231], v5, s[48:51], 0 offen offset:800
    buffer_load_dwordx4 v[232:235], v5, s[48:51], 0 offen offset:832
    buffer_load_dwordx4 v[236:239], v5, s[48:51], 0 offen offset:864
    v_add_u32 v6, 0, v0
    v_and_b32 v7, 15, v6
    v_bfe_u32 v8, v6, 4, 1
    v_lshrrev_b32 v9, 5, v6
    v_cmp_le_u32 vcc, 28, v9
    s_nop 1
    v_cndmask_b32 v10, 0, 1, vcc
    v_mul_u32_u24 v11, 28, v10
    v_sub_u32 v9, v9, v11
    v_lshlrev_b32 v11, 4, v9
    v_lshl_add_u32 v11, v8, 3, v11
    v_mul_u32_u24 v11, 2688, v11
    v_mul_u32_u24 v12, 896, v10
    v_add_u32 v11, v11, v12
    s_mul_i32 s7, s4, 56
    s_add_u32 s7, s7, 896
    v_add_u32 v11, s7, v11
    v_lshl_add_u32 v11, v7, 2, v11
    v_cmp_gt_u32 vcc, 14, v7
    v_mov_b32 v12, 0x7fffffff
    s_nop 1
    v_cndmask_b32 v11, v12, v11, vcc
    buffer_load_dword v16, v11, s[52:55], 0 offen offset:0
    buffer_load_dword v17, v11, s[52:55], 0 offen offset:2688
    v_add_u32 v11, 5376, v11
    buffer_load_dword v18, v11, s[52:55], 0 offen offset:0
    buffer_load_dword v19, v11, s[52:55], 0 offen offset:2688
    v_add_u32 v11, 5376, v11
    buffer_load_dword v20, v11, s[52:55], 0 offen offset:0
    buffer_load_dword v21, v11, s[52:55], 0 offen offset:2688
    v_add_u32 v11, 5376, v11
    buffer_load_dword v22, v11, s[52:55], 0 offen offset:0
    buffer_load_dword v23, v11, s[52:55], 0 offen offset:2688
    s_waitcnt vmcnt(0)
    v_and_b32 v13, 0xffff, v16
    v_lshl_or_b32 v24, v17, 16, v13
    v_lshrrev_b32 v13, 16, v16
    v_and_b32 v14, 0xffff0000, v17
    v_or_b32 v28, v13, v14
    v_and_b32 v13, 0xffff, v18
    v_lshl_or_b32 v25, v19, 16, v13
    v_lshrrev_b32 v13, 16, v18
    v_and_b32 v14, 0xffff0000, v19
    v_or_b32 v29, v13, v14
    v_and_b32 v13, 0xffff, v20
    v_lshl_or_b32 v26, v21, 16, v13
    v_lshrrev_b32 v13, 16, v20
    v_and_b32 v14, 0xffff0000, v21
    v_or_b32 v30, v13, v14
    v_and_b32 v13, 0xffff, v22
    v_lshl_or_b32 v27, v23, 16, v13
    v_lshrrev_b32 v13, 16, v22
    v_and_b32 v14, 0xffff0000, v23
    v_or_b32 v31, v13, v14
    v_mul_u32_u24 v12, 28672, v10
    v_lshl_add_u32 v12, v9, 10, v12
    v_lshl_add_u32 v12, v8, 9, v12
    v_lshl_add_u32 v12, v7, 5, v12
    ds_write_b128 v12, v[24:27]
    ds_write_b128 v12, v[28:31] offset:16
    v_add_u32 v6, 256, v0
    v_and_b32 v7, 15, v6
    v_bfe_u32 v8, v6, 4, 1
    v_lshrrev_b32 v9, 5, v6
    v_cmp_le_u32 vcc, 28, v9
    s_nop 1
    v_cndmask_b32 v10, 0, 1, vcc
    v_mul_u32_u24 v11, 28, v10
    v_sub_u32 v9, v9, v11
    v_lshlrev_b32 v11, 4, v9
    v_lshl_add_u32 v11, v8, 3, v11
    v_mul_u32_u24 v11, 2688, v11
    v_mul_u32_u24 v12, 896, v10
    v_add_u32 v11, v11, v12
    s_mul_i32 s7, s4, 56
    s_add_u32 s7, s7, 896
    v_add_u32 v11, s7, v11
    v_lshl_add_u32 v11, v7, 2, v11
    v_cmp_gt_u32 vcc, 14, v7
    v_mov_b32 v12, 0x7fffffff
    s_nop 1
    v_cndmask_b32 v11, v12, v11, vcc
    buffer_load_dword v16, v11, s[52:55], 0 offen offset:0
    buffer_load_dword v17, v11, s[52:55], 0 offen offset:2688
    v_add_u32 v11, 5376, v11
    buffer_load_dword v18, v11, s[52:55], 0 offen offset:0
    buffer_load_dword v19, v11, s[52:55], 0 offen offset:2688
    v_add_u32 v11, 5376, v11
    buffer_load_dword v20, v11, s[52:55], 0 offen offset:0
    buffer_load_dword v21, v11, s[52:55], 0 offen offset:2688
    v_add_u32 v11, 5376, v11
    buffer_load_dword v22, v11, s[52:55], 0 offen offset:0
    buffer_load_dword v23, v11, s[52:55], 0 offen offset:2688
    s_waitcnt vmcnt(0)
    v_and_b32 v13, 0xffff, v16
    v_lshl_or_b32 v24, v17, 16, v13
    v_lshrrev_b32 v13, 16, v16
    v_and_b32 v14, 0xffff0000, v17
    v_or_b32 v28, v13, v14
    v_and_b32 v13, 0xffff, v18
    v_lshl_or_b32 v25, v19, 16, v13
    v_lshrrev_b32 v13, 16, v18
    v_and_b32 v14, 0xffff0000, v19
    v_or_b32 v29, v13, v14
    v_and_b32 v13, 0xffff, v20
    v_lshl_or_b32 v26, v21, 16, v13
    v_lshrrev_b32 v13, 16, v20
    v_and_b32 v14, 0xffff0000, v21
    v_or_b32 v30, v13, v14
    v_and_b32 v13, 0xffff, v22
    v_lshl_or_b32 v27, v23, 16, v13
    v_lshrrev_b32 v13, 16, v22
    v_and_b32 v14, 0xffff0000, v23
    v_or_b32 v31, v13, v14
    v_mul_u32_u24 v12, 28672, v10
    v_lshl_add_u32 v12, v9, 10, v12
    v_lshl_add_u32 v12, v8, 9, v12
    v_lshl_add_u32 v12, v7, 5, v12
    ds_write_b128 v12, v[24:27]
    ds_write_b128 v12, v[28:31] offset:16
    v_add_u32 v6, 512, v0
    v_and_b32 v7, 15, v6
    v_bfe_u32 v8, v6, 4, 1
    v_lshrrev_b32 v9, 5, v6
    v_cmp_le_u32 vcc, 28, v9
    s_nop 1
    v_cndmask_b32 v10, 0, 1, vcc
    v_mul_u32_u24 v11, 28, v10
    v_sub_u32 v9, v9, v11
    v_lshlrev_b32 v11, 4, v9
    v_lshl_add_u32 v11, v8, 3, v11
    v_mul_u32_u24 v11, 2688, v11
    v_mul_u32_u24 v12, 896, v10
    v_add_u32 v11, v11, v12
    s_mul_i32 s7, s4, 56
    s_add_u32 s7, s7, 896
    v_add_u32 v11, s7, v11
    v_lshl_add_u32 v11, v7, 2, v11
    v_cmp_gt_u32 vcc, 14, v7
    v_mov_b32 v12, 0x7fffffff
    s_nop 1
    v_cndmask_b32 v11, v12, v11, vcc
    buffer_load_dword v16, v11, s[52:55], 0 offen offset:0
    buffer_load_dword v17, v11, s[52:55], 0 offen offset:2688
    v_add_u32 v11, 5376, v11
    buffer_load_dword v18, v11, s[52:55], 0 offen offset:0
    buffer_load_dword v19, v11, s[52:55], 0 offen offset:2688
    v_add_u32 v11, 5376, v11
    buffer_load_dword v20, v11, s[52:55], 0 offen offset:0
    buffer_load_dword v21, v11, s[52:55], 0 offen offset:2688
    v_add_u32 v11, 5376, v11
    buffer_load_dword v22, v11, s[52:55], 0 offen offset:0
    buffer_load_dword v23, v11, s[52:55], 0 offen offset:2688
    s_waitcnt vmcnt(0)
    v_and_b32 v13, 0xffff, v16
    v_lshl_or_b32 v24, v17, 16, v13
    v_lshrrev_b32 v13, 16, v16
    v_and_b32 v14, 0xffff0000, v17
    v_or_b32 v28, v13, v14
    v_and_b32 v13, 0xffff, v18
    v_lshl_or_b32 v25, v19, 16, v13
    v_lshrrev_b32 v13, 16, v18
    v_and_b32 v14, 0xffff0000, v19
    v_or_b32 v29, v13, v14
    v_and_b32 v13, 0xffff, v20
    v_lshl_or_b32 v26, v21, 16, v13
    v_lshrrev_b32 v13, 16, v20
    v_and_b32 v14, 0xffff0000, v21
    v_or_b32 v30, v13, v14
    v_and_b32 v13, 0xffff, v22
    v_lshl_or_b32 v27, v23, 16, v13
    v_lshrrev_b32 v13, 16, v22
    v_and_b32 v14, 0xffff0000, v23
    v_or_b32 v31, v13, v14
    v_mul_u32_u24 v12, 28672, v10
    v_lshl_add_u32 v12, v9, 10, v12
    v_lshl_add_u32 v12, v8, 9, v12
    v_lshl_add_u32 v12, v7, 5, v12
    ds_write_b128 v12, v[24:27]
    ds_write_b128 v12, v[28:31] offset:16
    v_add_u32 v6, 768, v0
    v_and_b32 v7, 15, v6
    v_bfe_u32 v8, v6, 4, 1
    v_lshrrev_b32 v9, 5, v6
    v_cmp_le_u32 vcc, 28, v9
    s_nop 1
    v_cndmask_b32 v10, 0, 1, vcc
    v_mul_u32_u24 v11, 28, v10
    v_sub_u32 v9, v9, v11
    v_lshlrev_b32 v11, 4, v9
    v_lshl_add_u32 v11, v8, 3, v11
    v_mul_u32_u24 v11, 2688, v11
    v_mul_u32_u24 v12, 896, v10
    v_add_u32 v11, v11, v12
    s_mul_i32 s7, s4, 56
    s_add_u32 s7, s7, 896
    v_add_u32 v11, s7, v11
    v_lshl_add_u32 v11, v7, 2, v11
    v_cmp_gt_u32 vcc, 14, v7
    v_mov_b32 v12, 0x7fffffff
    s_nop 1
    v_cndmask_b32 v11, v12, v11, vcc
    buffer_load_dword v16, v11, s[52:55], 0 offen offset:0
    buffer_load_dword v17, v11, s[52:55], 0 offen offset:2688
    v_add_u32 v11, 5376, v11
    buffer_load_dword v18, v11, s[52:55], 0 offen offset:0
    buffer_load_dword v19, v11, s[52:55], 0 offen offset:2688
    v_add_u32 v11, 5376, v11
    buffer_load_dword v20, v11, s[52:55], 0 offen offset:0
    buffer_load_dword v21, v11, s[52:55], 0 offen offset:2688
    v_add_u32 v11, 5376, v11
    buffer_load_dword v22, v11, s[52:55], 0 offen offset:0
    buffer_load_dword v23, v11, s[52:55], 0 offen offset:2688
    s_waitcnt vmcnt(0)
    v_and_b32 v13, 0xffff, v16
    v_lshl_or_b32 v24, v17, 16, v13
    v_lshrrev_b32 v13, 16, v16
    v_and_b32 v14, 0xffff0000, v17
    v_or_b32 v28, v13, v14
    v_and_b32 v13, 0xffff, v18
    v_lshl_or_b32 v25, v19, 16, v13
    v_lshrrev_b32 v13, 16, v18
    v_and_b32 v14, 0xffff0000, v19
    v_or_b32 v29, v13, v14
    v_and_b32 v13, 0xffff, v20
    v_lshl_or_b32 v26, v21, 16, v13
    v_lshrrev_b32 v13, 16, v20
    v_and_b32 v14, 0xffff0000, v21
    v_or_b32 v30, v13, v14
    v_and_b32 v13, 0xffff, v22
    v_lshl_or_b32 v27, v23, 16, v13
    v_lshrrev_b32 v13, 16, v22
    v_and_b32 v14, 0xffff0000, v23
    v_or_b32 v31, v13, v14
    v_mul_u32_u24 v12, 28672, v10
    v_lshl_add_u32 v12, v9, 10, v12
    v_lshl_add_u32 v12, v8, 9, v12
    v_lshl_add_u32 v12, v7, 5, v12
    ds_write_b128 v12, v[24:27]
    ds_write_b128 v12, v[28:31] offset:16
    v_add_u32 v6, 1024, v0
    v_and_b32 v7, 15, v6
    v_bfe_u32 v8, v6, 4, 1
    v_lshrrev_b32 v9, 5, v6
    v_cmp_le_u32 vcc, 28, v9
    s_nop 1
    v_cndmask_b32 v10, 0, 1, vcc
    v_mul_u32_u24 v11, 28, v10
    v_sub_u32 v9, v9, v11
    v_lshlrev_b32 v11, 4, v9
    v_lshl_add_u32 v11, v8, 3, v11
    v_mul_u32_u24 v11, 2688, v11
    v_mul_u32_u24 v12, 896, v10
    v_add_u32 v11, v11, v12
    s_mul_i32 s7, s4, 56
    s_add_u32 s7, s7, 896
    v_add_u32 v11, s7, v11
    v_lshl_add_u32 v11, v7, 2, v11
    v_cmp_gt_u32 vcc, 14, v7
    v_mov_b32 v12, 0x7fffffff
    s_nop 1
    v_cndmask_b32 v11, v12, v11, vcc
    buffer_load_dword v16, v11, s[52:55], 0 offen offset:0
    buffer_load_dword v17, v11, s[52:55], 0 offen offset:2688
    v_add_u32 v11, 5376, v11
    buffer_load_dword v18, v11, s[52:55], 0 offen offset:0
    buffer_load_dword v19, v11, s[52:55], 0 offen offset:2688
    v_add_u32 v11, 5376, v11
    buffer_load_dword v20, v11, s[52:55], 0 offen offset:0
    buffer_load_dword v21, v11, s[52:55], 0 offen offset:2688
    v_add_u32 v11, 5376, v11
    buffer_load_dword v22, v11, s[52:55], 0 offen offset:0
    buffer_load_dword v23, v11, s[52:55], 0 offen offset:2688
    s_waitcnt vmcnt(0)
    v_and_b32 v13, 0xffff, v16
    v_lshl_or_b32 v24, v17, 16, v13
    v_lshrrev_b32 v13, 16, v16
    v_and_b32 v14, 0xffff0000, v17
    v_or_b32 v28, v13, v14
    v_and_b32 v13, 0xffff, v18
    v_lshl_or_b32 v25, v19, 16, v13
    v_lshrrev_b32 v13, 16, v18
    v_and_b32 v14, 0xffff0000, v19
    v_or_b32 v29, v13, v14
    v_and_b32 v13, 0xffff, v20
    v_lshl_or_b32 v26, v21, 16, v13
    v_lshrrev_b32 v13, 16, v20
    v_and_b32 v14, 0xffff0000, v21
    v_or_b32 v30, v13, v14
    v_and_b32 v13, 0xffff, v22
    v_lshl_or_b32 v27, v23, 16, v13
    v_lshrrev_b32 v13, 16, v22
    v_and_b32 v14, 0xffff0000, v23
    v_or_b32 v31, v13, v14
    v_mul_u32_u24 v12, 28672, v10
    v_lshl_add_u32 v12, v9, 10, v12
    v_lshl_add_u32 v12, v8, 9, v12
    v_lshl_add_u32 v12, v7, 5, v12
    ds_write_b128 v12, v[24:27]
    ds_write_b128 v12, v[28:31] offset:16
    v_add_u32 v6, 1280, v0
    v_and_b32 v7, 15, v6
    v_bfe_u32 v8, v6, 4, 1
    v_lshrrev_b32 v9, 5, v6
    v_cmp_le_u32 vcc, 28, v9
    s_nop 1
    v_cndmask_b32 v10, 0, 1, vcc
    v_mul_u32_u24 v11, 28, v10
    v_sub_u32 v9, v9, v11
    v_lshlrev_b32 v11, 4, v9
    v_lshl_add_u32 v11, v8, 3, v11
    v_mul_u32_u24 v11, 2688, v11
    v_mul_u32_u24 v12, 896, v10
    v_add_u32 v11, v11, v12
    s_mul_i32 s7, s4, 56
    s_add_u32 s7, s7, 896
    v_add_u32 v11, s7, v11
    v_lshl_add_u32 v11, v7, 2, v11
    v_cmp_gt_u32 vcc, 14, v7
    v_mov_b32 v12, 0x7fffffff
    s_nop 1
    v_cndmask_b32 v11, v12, v11, vcc
    buffer_load_dword v16, v11, s[52:55], 0 offen offset:0
    buffer_load_dword v17, v11, s[52:55], 0 offen offset:2688
    v_add_u32 v11, 5376, v11
    buffer_load_dword v18, v11, s[52:55], 0 offen offset:0
    buffer_load_dword v19, v11, s[52:55], 0 offen offset:2688
    v_add_u32 v11, 5376, v11
    buffer_load_dword v20, v11, s[52:55], 0 offen offset:0
    buffer_load_dword v21, v11, s[52:55], 0 offen offset:2688
    v_add_u32 v11, 5376, v11
    buffer_load_dword v22, v11, s[52:55], 0 offen offset:0
    buffer_load_dword v23, v11, s[52:55], 0 offen offset:2688
    s_waitcnt vmcnt(0)
    v_and_b32 v13, 0xffff, v16
    v_lshl_or_b32 v24, v17, 16, v13
    v_lshrrev_b32 v13, 16, v16
    v_and_b32 v14, 0xffff0000, v17
    v_or_b32 v28, v13, v14
    v_and_b32 v13, 0xffff, v18
    v_lshl_or_b32 v25, v19, 16, v13
    v_lshrrev_b32 v13, 16, v18
    v_and_b32 v14, 0xffff0000, v19
    v_or_b32 v29, v13, v14
    v_and_b32 v13, 0xffff, v20
    v_lshl_or_b32 v26, v21, 16, v13
    v_lshrrev_b32 v13, 16, v20
    v_and_b32 v14, 0xffff0000, v21
    v_or_b32 v30, v13, v14
    v_and_b32 v13, 0xffff, v22
    v_lshl_or_b32 v27, v23, 16, v13
    v_lshrrev_b32 v13, 16, v22
    v_and_b32 v14, 0xffff0000, v23
    v_or_b32 v31, v13, v14
    v_mul_u32_u24 v12, 28672, v10
    v_lshl_add_u32 v12, v9, 10, v12
    v_lshl_add_u32 v12, v8, 9, v12
    v_lshl_add_u32 v12, v7, 5, v12
    ds_write_b128 v12, v[24:27]
    ds_write_b128 v12, v[28:31] offset:16
    v_add_u32 v6, 1536, v0
    v_and_b32 v7, 15, v6
    v_bfe_u32 v8, v6, 4, 1
    v_lshrrev_b32 v9, 5, v6
    v_cmp_le_u32 vcc, 28, v9
    s_nop 1
    v_cndmask_b32 v10, 0, 1, vcc
    v_mul_u32_u24 v11, 28, v10
    v_sub_u32 v9, v9, v11
    v_lshlrev_b32 v11, 4, v9
    v_lshl_add_u32 v11, v8, 3, v11
    v_mul_u32_u24 v11, 2688, v11
    v_mul_u32_u24 v12, 896, v10
    v_add_u32 v11, v11, v12
    s_mul_i32 s7, s4, 56
    s_add_u32 s7, s7, 896
    v_add_u32 v11, s7, v11
    v_lshl_add_u32 v11, v7, 2, v11
    v_cmp_gt_u32 vcc, 14, v7
    v_mov_b32 v12, 0x7fffffff
    s_nop 1
    v_cndmask_b32 v11, v12, v11, vcc
    buffer_load_dword v16, v11, s[52:55], 0 offen offset:0
    buffer_load_dword v17, v11, s[52:55], 0 offen offset:2688
    v_add_u32 v11, 5376, v11
    buffer_load_dword v18, v11, s[52:55], 0 offen offset:0
    buffer_load_dword v19, v11, s[52:55], 0 offen offset:2688
    v_add_u32 v11, 5376, v11
    buffer_load_dword v20, v11, s[52:55], 0 offen offset:0
    buffer_load_dword v21, v11, s[52:55], 0 offen offset:2688
    v_add_u32 v11, 5376, v11
    buffer_load_dword v22, v11, s[52:55], 0 offen offset:0
    buffer_load_dword v23, v11, s[52:55], 0 offen offset:2688
    s_waitcnt vmcnt(0)
    v_and_b32 v13, 0xffff, v16
    v_lshl_or_b32 v24, v17, 16, v13
    v_lshrrev_b32 v13, 16, v16
    v_and_b32 v14, 0xffff0000, v17
    v_or_b32 v28, v13, v14
    v_and_b32 v13, 0xffff, v18
    v_lshl_or_b32 v25, v19, 16, v13
    v_lshrrev_b32 v13, 16, v18
    v_and_b32 v14, 0xffff0000, v19
    v_or_b32 v29, v13, v14
    v_and_b32 v13, 0xffff, v20
    v_lshl_or_b32 v26, v21, 16, v13
    v_lshrrev_b32 v13, 16, v20
    v_and_b32 v14, 0xffff0000, v21
    v_or_b32 v30, v13, v14
    v_and_b32 v13, 0xffff, v22
    v_lshl_or_b32 v27, v23, 16, v13
    v_lshrrev_b32 v13, 16, v22
    v_and_b32 v14, 0xffff0000, v23
    v_or_b32 v31, v13, v14
    v_mul_u32_u24 v12, 28672, v10
    v_lshl_add_u32 v12, v9, 10, v12
    v_lshl_add_u32 v12, v8, 9, v12
    v_lshl_add_u32 v12, v7, 5, v12
    ds_write_b128 v12, v[24:27]
    ds_write_b128 v12, v[28:31] offset:16
    s_waitcnt lgkmcnt(0)
    s_barrier
    v_lshlrev_b32 v2, 4, v1
    v_mov_b32 v64, 0
    v_mov_b32 v65, 0
    v_mov_b32 v66, 0
    v_mov_b32 v67, 0
    v_mov_b32 v68, 0
    v_mov_b32 v69, 0
    v_mov_b32 v70, 0
    v_mov_b32 v71, 0
    v_mov_b32 v72, 0
    v_mov_b32 v73, 0
    v_mov_b32 v74, 0
    v_mov_b32 v75, 0
    v_mov_b32 v76, 0
    v_mov_b32 v77, 0
    v_mov_b32 v78, 0
    v_mov_b32 v79, 0
    v_mov_b32 v80, 0
    v_mov_b32 v81, 0
    v_mov_b32 v82, 0
    v_mov_b32 v83, 0
    v_mov_b32 v84, 0
    v_mov_b32 v85, 0
    v_mov_b32 v86, 0
    v_mov_b32 v87, 0
    v_mov_b32 v88, 0
    v_mov_b32 v89, 0
    v_mov_b32 v90, 0
    v_mov_b32 v91, 0
    v_mov_b32 v92, 0
    v_mov_b32 v93, 0
    v_mov_b32 v94, 0
    v_mov_b32 v95, 0
    v_mov_b32 v96, 0
    v_mov_b32 v97, 0
    v_mov_b32 v98, 0
    v_mov_b32 v99, 0
    v_mov_b32 v100, 0
    v_mov_b32 v101, 0
    v_mov_b32 v102, 0
    v_mov_b32 v103, 0
    v_mov_b32 v104, 0
    v_mov_b32 v105, 0
    v_mov_b32 v106, 0
    v_mov_b32 v107, 0
    v_mov_b32 v108, 0
    v_mov_b32 v109, 0
    v_mov_b32 v110, 0
    v_mov_b32 v111, 0
    ds_read_b128 v[16:19], v2 offset:0
    ds_read_b128 v[20:23], v2 offset:28672
    s_waitcnt lgkmcnt(0)
    v_mfma_f32_32x32x16_bf16 v[64:79], v[16:19], v[128:131], v[64:79]
    v_mfma_f32_32x32x16_bf16 v[80:95], v[128:131], v[20:23], v[80:95]
    s_nop 4
    ds_read_b128 v[16:19], v2 offset:1024
    ds_read_b128 v[20:23], v2 offset:29696
    s_waitcnt lgkmcnt(0)
    v_mfma_f32_32x32x16_bf16 v[64:79], v[16:19], v[132:135], v[64:79]
    v_mfma_f32_32x32x16_bf16 v[80:95], v[132:135], v[20:23], v[80:95]
    s_nop 4
    ds_read_b128 v[16:19], v2 offset:2048
    ds_read_b128 v[20:23], v2 offset:30720
    s_waitcnt lgkmcnt(0)
    v_mfma_f32_32x32x16_bf16 v[64:79], v[16:19], v[136:139], v[64:79]
    v_mfma_f32_32x32x16_bf16 v[80:95], v[136:139], v[20:23], v[80:95]
    s_nop 4
    ds_read_b128 v[16:19], v2 offset:3072
    ds_read_b128 v[20:23], v2 offset:31744
    s_waitcnt lgkmcnt(0)
    v_mfma_f32_32x32x16_bf16 v[64:79], v[16:19], v[140:143], v[64:79]
    v_mfma_f32_32x32x16_bf16 v[80:95], v[140:143], v[20:23], v[80:95]
    s_nop 4
    ds_read_b128 v[16:19], v2 offset:4096
    ds_read_b128 v[20:23], v2 offset:32768
    s_waitcnt lgkmcnt(0)
    v_mfma_f32_32x32x16_bf16 v[64:79], v[16:19], v[144:147], v[64:79]
    v_mfma_f32_32x32x16_bf16 v[80:95], v[144:147], v[20:23], v[80:95]
    s_nop 4
    ds_read_b128 v[16:19], v2 offset:5120
    ds_read_b128 v[20:23], v2 offset:33792
    s_waitcnt lgkmcnt(0)
    v_mfma_f32_32x32x16_bf16 v[64:79], v[16:19], v[148:151], v[64:79]
    v_mfma_f32_32x32x16_bf16 v[80:95], v[148:151], v[20:23], v[80:95]
    s_nop 4
    ds_read_b128 v[16:19], v2 offset:6144
    ds_read_b128 v[20:23], v2 offset:34816
    s_waitcnt lgkmcnt(0)
    v_mfma_f32_32x32x16_bf16 v[64:79], v[16:19], v[152:155], v[64:79]
    v_mfma_f32_32x32x16_bf16 v[80:95], v[152:155], v[20:23], v[80:95]
    s_nop 4
    ds_read_b128 v[16:19], v2 offset:7168
    ds_read_b128 v[20:23], v2 offset:35840
    s_waitcnt lgkmcnt(0)
    v_mfma_f32_32x32x16_bf16 v[64:79], v[16:19], v[156:159], v[64:79]
    v_mfma_f32_32x32x16_bf16 v[80:95], v[156:159], v[20:23], v[80:95]
    s_nop 4
    ds_read_b128 v[16:19], v2 offset:8192
    ds_read_b128 v[20:23], v2 offset:36864
    s_waitcnt lgkmcnt(0)
    v_mfma_f32_32x32x16_bf16 v[64:79], v[16:19], v[160:163], v[64:79]
    v_mfma_f32_32x32x16_bf16 v[80:95], v[160:163], v[20:23], v[80:95]
    s_nop 4
    ds_read_b128 v[16:19], v2 offset:9216
    ds_read_b128 v[20:23], v2 offset:37888
    s_waitcnt lgkmcnt(0)
    v_mfma_f32_32x32x16_bf16 v[64:79], v[16:19], v[164:167], v[64:79]
    v_mfma_f32_32x32x16_bf16 v[80:95], v[164:167], v[20:23], v[80:95]
    s_nop 4
    ds_read_b128 v[16:19], v2 offset:10240
    ds_read_b128 v[20:23], v2 offset:38912
    s_waitcnt lgkmcnt(0)
    v_mfma_f32_32x32x16_bf16 v[64:79], v[16:19], v[168:171], v[64:79]
    v_mfma_f32_32x32x16_bf16 v[80:95], v[168:171], v[20:23], v[80:95]
    s_nop 4
    ds_read_b128 v[16:19], v2 offset:11264
    ds_read_b128 v[20:23], v2 offset:39936
    s_waitcnt lgkmcnt(0)
    v_mfma_f32_32x32x16_bf16 v[64:79], v[16:19], v[172:175], v[64:79]
    v_mfma_f32_32x32x16_bf16 v[80:95], v[172:175], v[20:23], v[80:95]
    s_nop 4
    ds_read_b128 v[16:19], v2 offset:12288
    ds_read_b128 v[20:23], v2 offset:40960
    s_waitcnt lgkmcnt(0)
    v_mfma_f32_32x32x16_bf16 v[64:79], v[16:19], v[176:179], v[64:79]
    v_mfma_f32_32x32x16_bf16 v[80:95], v[176:179], v[20:23], v[80:95]
    s_nop 4
    ds_read_b128 v[16:19], v2 offset:13312
    ds_read_b128 v[20:23], v2 offset:41984
    s_waitcnt lgkmcnt(0)
    v_mfma_f32_32x32x16_bf16 v[64:79], v[16:19], v[180:183], v[64:79]
    v_mfma_f32_32x32x16_bf16 v[80:95], v[180:183], v[20:23], v[80:95]
    s_nop 4
    ds_read_b128 v[16:19], v2 offset:14336
    ds_read_b128 v[20:23], v2 offset:43008
    s_waitcnt lgkmcnt(0)
    v_mfma_f32_32x32x16_bf16 v[64:79], v[16:19], v[184:187], v[64:79]
    v_mfma_f32_32x32x16_bf16 v[80:95], v[184:187], v[20:23], v[80:95]
    s_nop 4
    ds_read_b128 v[16:19], v2 offset:15360
    ds_read_b128 v[20:23], v2 offset:44032
    s_waitcnt lgkmcnt(0)
    v_mfma_f32_32x32x16_bf16 v[64:79], v[16:19], v[188:191], v[64:79]
    v_mfma_f32_32x32x16_bf16 v[80:95], v[188:191], v[20:23], v[80:95]
    s_nop 4
    ds_read_b128 v[16:19], v2 offset:16384
    ds_read_b128 v[20:23], v2 offset:45056
    s_waitcnt lgkmcnt(0)
    v_mfma_f32_32x32x16_bf16 v[64:79], v[16:19], v[192:195], v[64:79]
    v_mfma_f32_32x32x16_bf16 v[80:95], v[192:195], v[20:23], v[80:95]
    s_nop 4
    ds_read_b128 v[16:19], v2 offset:17408
    ds_read_b128 v[20:23], v2 offset:46080
    s_waitcnt lgkmcnt(0)
    v_mfma_f32_32x32x16_bf16 v[64:79], v[16:19], v[196:199], v[64:79]
    v_mfma_f32_32x32x16_bf16 v[80:95], v[196:199], v[20:23], v[80:95]
    s_nop 4
    ds_read_b128 v[16:19], v2 offset:18432
    ds_read_b128 v[20:23], v2 offset:47104
    s_waitcnt lgkmcnt(0)
    v_mfma_f32_32x32x16_bf16 v[64:79], v[16:19], v[200:203], v[64:79]
    v_mfma_f32_32x32x16_bf16 v[80:95], v[200:203], v[20:23], v[80:95]
    s_nop 4
    ds_read_b128 v[16:19], v2 offset:19456
    ds_read_b128 v[20:23], v2 offset:48128
    s_waitcnt lgkmcnt(0)
    v_mfma_f32_32x32x16_bf16 v[64:79], v[16:19], v[204:207], v[64:79]
    v_mfma_f32_32x32x16_bf16 v[80:95], v[204:207], v[20:23], v[80:95]
    s_nop 4
    ds_read_b128 v[16:19], v2 offset:20480
    ds_read_b128 v[20:23], v2 offset:49152
    s_waitcnt lgkmcnt(0)
    v_mfma_f32_32x32x16_bf16 v[64:79], v[16:19], v[208:211], v[64:79]
    v_mfma_f32_32x32x16_bf16 v[80:95], v[208:211], v[20:23], v[80:95]
    s_nop 4
    ds_read_b128 v[16:19], v2 offset:21504
    ds_read_b128 v[20:23], v2 offset:50176
    s_waitcnt lgkmcnt(0)
    v_mfma_f32_32x32x16_bf16 v[64:79], v[16:19], v[212:215], v[64:79]
    v_mfma_f32_32x32x16_bf16 v[80:95], v[212:215], v[20:23], v[80:95]
    s_nop 4
    ds_read_b128 v[16:19], v2 offset:22528
    ds_read_b128 v[20:23], v2 offset:51200
    s_waitcnt lgkmcnt(0)
    v_mfma_f32_32x32x16_bf16 v[64:79], v[16:19], v[216:219], v[64:79]
    v_mfma_f32_32x32x16_bf16 v[80:95], v[216:219], v[20:23], v[80:95]
    s_nop 4
    ds_read_b128 v[16:19], v2 offset:23552
    ds_read_b128 v[20:23], v2 offset:52224
    s_waitcnt lgkmcnt(0)
    v_mfma_f32_32x32x16_bf16 v[64:79], v[16:19], v[220:223], v[64:79]
    v_mfma_f32_32x32x16_bf16 v[80:95], v[220:223], v[20:23], v[80:95]
    s_nop 4
    ds_read_b128 v[16:19], v2 offset:24576
    ds_read_b128 v[20:23], v2 offset:53248
    s_waitcnt lgkmcnt(0)
    v_mfma_f32_32x32x16_bf16 v[64:79], v[16:19], v[224:227], v[64:79]
    v_mfma_f32_32x32x16_bf16 v[80:95], v[224:227], v[20:23], v[80:95]
    s_nop 4
    ds_read_b128 v[16:19], v2 offset:25600
    ds_read_b128 v[20:23], v2 offset:54272
    s_waitcnt lgkmcnt(0)
    v_mfma_f32_32x32x16_bf16 v[64:79], v[16:19], v[228:231], v[64:79]
    v_mfma_f32_32x32x16_bf16 v[80:95], v[228:231], v[20:23], v[80:95]
    s_nop 4
    ds_read_b128 v[16:19], v2 offset:26624
    ds_read_b128 v[20:23], v2 offset:55296
    s_waitcnt lgkmcnt(0)
    v_mfma_f32_32x32x16_bf16 v[64:79], v[16:19], v[232:235], v[64:79]
    v_mfma_f32_32x32x16_bf16 v[80:95], v[232:235], v[20:23], v[80:95]
    s_nop 4
    ds_read_b128 v[16:19], v2 offset:27648
    ds_read_b128 v[20:23], v2 offset:56320
    s_waitcnt lgkmcnt(0)
    v_mfma_f32_32x32x16_bf16 v[64:79], v[16:19], v[236:239], v[64:79]
    v_mfma_f32_32x32x16_bf16 v[80:95], v[236:239], v[20:23], v[80:95]
    s_nop 4
    s_barrier
    v_add_u32 v6, 0, v0
    v_and_b32 v7, 15, v6
    v_bfe_u32 v8, v6, 4, 1
    v_lshrrev_b32 v9, 5, v6
    v_cmp_le_u32 vcc, 28, v9
    s_nop 1
    v_cndmask_b32 v10, 0, 1, vcc
    v_mul_u32_u24 v11, 28, v10
    v_sub_u32 v9, v9, v11
    v_lshlrev_b32 v11, 4, v9
    v_lshl_add_u32 v11, v8, 3, v11
    v_mul_u32_u24 v11, 2688, v11
    v_mul_u32_u24 v12, 0, v10
    v_add_u32 v11, v11, v12
    s_mul_i32 s7, s4, 56
    s_add_u32 s7, s7, 0
    v_add_u32 v11, s7, v11
    v_lshl_add_u32 v11, v7, 2, v11
    v_cmp_gt_u32 vcc, 14, v7
    v_mov_b32 v12, 0x7fffffff
    s_nop 1
    v_cndmask_b32 v11, v12, v11, vcc
    buffer_load_dword v16, v11, s[52:55], 0 offen offset:0
    buffer_load_dword v17, v11, s[52:55], 0 offen offset:2688
    v_add_u32 v11, 5376, v11
    buffer_load_dword v18, v11, s[52:55], 0 offen offset:0
    buffer_load_dword v19, v11, s[52:55], 0 offen offset:2688
    v_add_u32 v11, 5376, v11
    buffer_load_dword v20, v11, s[52:55], 0 offen offset:0
    buffer_load_dword v21, v11, s[52:55], 0 offen offset:2688
    v_add_u32 v11, 5376, v11
    buffer_load_dword v22, v11, s[52:55], 0 offen offset:0
    buffer_load_dword v23, v11, s[52:55], 0 offen offset:2688
    s_waitcnt vmcnt(0)
    v_and_b32 v13, 0xffff, v16
    v_lshl_or_b32 v24, v17, 16, v13
    v_lshrrev_b32 v13, 16, v16
    v_and_b32 v14, 0xffff0000, v17
    v_or_b32 v28, v13, v14
    v_and_b32 v13, 0xffff, v18
    v_lshl_or_b32 v25, v19, 16, v13
    v_lshrrev_b32 v13, 16, v18
    v_and_b32 v14, 0xffff0000, v19
    v_or_b32 v29, v13, v14
    v_and_b32 v13, 0xffff, v20
    v_lshl_or_b32 v26, v21, 16, v13
    v_lshrrev_b32 v13, 16, v20
    v_and_b32 v14, 0xffff0000, v21
    v_or_b32 v30, v13, v14
    v_and_b32 v13, 0xffff, v22
    v_lshl_or_b32 v27, v23, 16, v13
    v_lshrrev_b32 v13, 16, v22
    v_and_b32 v14, 0xffff0000, v23
    v_or_b32 v31, v13, v14
    v_mul_u32_u24 v12, 28672, v10
    v_lshl_add_u32 v12, v9, 10, v12
    v_lshl_add_u32 v12, v8, 9, v12
    v_lshl_add_u32 v12, v7, 5, v12
    ds_write_b128 v12, v[24:27]
    ds_write_b128 v12, v[28:31] offset:16
    v_add_u32 v6, 256, v0
    v_and_b32 v7, 15, v6
    v_bfe_u32 v8, v6, 4, 1
    v_lshrrev_b32 v9, 5, v6
    v_cmp_le_u32 vcc, 28, v9
    s_nop 1
    v_cndmask_b32 v10, 0, 1, vcc
    v_mul_u32_u24 v11, 28, v10
    v_sub_u32 v9, v9, v11
    v_lshlrev_b32 v11, 4, v9
    v_lshl_add_u32 v11, v8, 3, v11
    v_mul_u32_u24 v11, 2688, v11
    v_mul_u32_u24 v12, 0, v10
    v_add_u32 v11, v11, v12
    s_mul_i32 s7, s4, 56
    s_add_u32 s7, s7, 0
    v_add_u32 v11, s7, v11
    v_lshl_add_u32 v11, v7, 2, v11
    v_cmp_gt_u32 vcc, 14, v7
    v_mov_b32 v12, 0x7fffffff
    s_nop 1
    v_cndmask_b32 v11, v12, v11, vcc
    buffer_load_dword v16, v11, s[52:55], 0 offen offset:0
    buffer_load_dword v17, v11, s[52:55], 0 offen offset:2688
    v_add_u32 v11, 5376, v11
    buffer_load_dword v18, v11, s[52:55], 0 offen offset:0
    buffer_load_dword v19, v11, s[52:55], 0 offen offset:2688
    v_add_u32 v11, 5376, v11
    buffer_load_dword v20, v11, s[52:55], 0 offen offset:0
    buffer_load_dword v21, v11, s[52:55], 0 offen offset:2688
    v_add_u32 v11, 5376, v11
    buffer_load_dword v22, v11, s[52:55], 0 offen offset:0
    buffer_load_dword v23, v11, s[52:55], 0 offen offset:2688
    s_waitcnt vmcnt(0)
    v_and_b32 v13, 0xffff, v16
    v_lshl_or_b32 v24, v17, 16, v13
    v_lshrrev_b32 v13, 16, v16
    v_and_b32 v14, 0xffff0000, v17
    v_or_b32 v28, v13, v14
    v_and_b32 v13, 0xffff, v18
    v_lshl_or_b32 v25, v19, 16, v13
    v_lshrrev_b32 v13, 16, v18
    v_and_b32 v14, 0xffff0000, v19
    v_or_b32 v29, v13, v14
    v_and_b32 v13, 0xffff, v20
    v_lshl_or_b32 v26, v21, 16, v13
    v_lshrrev_b32 v13, 16, v20
    v_and_b32 v14, 0xffff0000, v21
    v_or_b32 v30, v13, v14
    v_and_b32 v13, 0xffff, v22
    v_lshl_or_b32 v27, v23, 16, v13
    v_lshrrev_b32 v13, 16, v22
    v_and_b32 v14, 0xffff0000, v23
    v_or_b32 v31, v13, v14
    v_mul_u32_u24 v12, 28672, v10
    v_lshl_add_u32 v12, v9, 10, v12
    v_lshl_add_u32 v12, v8, 9, v12
    v_lshl_add_u32 v12, v7, 5, v12
    ds_write_b128 v12, v[24:27]
    ds_write_b128 v12, v[28:31] offset:16
    v_add_u32 v6, 512, v0
    v_and_b32 v7, 15, v6
    v_bfe_u32 v8, v6, 4, 1
    v_lshrrev_b32 v9, 5, v6
    v_cmp_le_u32 vcc, 28, v9
    s_nop 1
    v_cndmask_b32 v10, 0, 1, vcc
    v_mul_u32_u24 v11, 28, v10
    v_sub_u32 v9, v9, v11
    v_lshlrev_b32 v11, 4, v9
    v_lshl_add_u32 v11, v8, 3, v11
    v_mul_u32_u24 v11, 2688, v11
    v_mul_u32_u24 v12, 0, v10
    v_add_u32 v11, v11, v12
    s_mul_i32 s7, s4, 56
    s_add_u32 s7, s7, 0
    v_add_u32 v11, s7, v11
    v_lshl_add_u32 v11, v7, 2, v11
    v_cmp_gt_u32 vcc, 14, v7
    v_mov_b32 v12, 0x7fffffff
    s_nop 1
    v_cndmask_b32 v11, v12, v11, vcc
    buffer_load_dword v16, v11, s[52:55], 0 offen offset:0
    buffer_load_dword v17, v11, s[52:55], 0 offen offset:2688
    v_add_u32 v11, 5376, v11
    buffer_load_dword v18, v11, s[52:55], 0 offen offset:0
    buffer_load_dword v19, v11, s[52:55], 0 offen offset:2688
    v_add_u32 v11, 5376, v11
    buffer_load_dword v20, v11, s[52:55], 0 offen offset:0
    buffer_load_dword v21, v11, s[52:55], 0 offen offset:2688
    v_add_u32 v11, 5376, v11
    buffer_load_dword v22, v11, s[52:55], 0 offen offset:0
    buffer_load_dword v23, v11, s[52:55], 0 offen offset:2688
    s_waitcnt vmcnt(0)
    v_and_b32 v13, 0xffff, v16
    v_lshl_or_b32 v24, v17, 16, v13
    v_lshrrev_b32 v13, 16, v16
    v_and_b32 v14, 0xffff0000, v17
    v_or_b32 v28, v13, v14
    v_and_b32 v13, 0xffff, v18
    v_lshl_or_b32 v25, v19, 16, v13
    v_lshrrev_b32 v13, 16, v18
    v_and_b32 v14, 0xffff0000, v19
    v_or_b32 v29, v13, v14
    v_and_b32 v13, 0xffff, v20
    v_lshl_or_b32 v26, v21, 16, v13
    v_lshrrev_b32 v13, 16, v20
    v_and_b32 v14, 0xffff0000, v21
    v_or_b32 v30, v13, v14
    v_and_b32 v13, 0xffff, v22
    v_lshl_or_b32 v27, v23, 16, v13
    v_lshrrev_b32 v13, 16, v22
    v_and_b32 v14, 0xffff0000, v23
    v_or_b32 v31, v13, v14
    v_mul_u32_u24 v12, 28672, v10
    v_lshl_add_u32 v12, v9, 10, v12
    v_lshl_add_u32 v12, v8, 9, v12
    v_lshl_add_u32 v12, v7, 5, v12
    ds_write_b128 v12, v[24:27]
    ds_write_b128 v12, v[28:31] offset:16
    v_add_u32 v6, 768, v0
    v_and_b32 v7, 15, v6
    v_bfe_u32 v8, v6, 4, 1
    v_lshrrev_b32 v9, 5, v6
    v_cmp_le_u32 vcc, 28, v9
    s_nop 1
    v_cndmask_b32 v10, 0, 1, vcc
    v_mul_u32_u24 v11, 28, v10
    v_sub_u32 v9, v9, v11
    v_lshlrev_b32 v11, 4, v9
    v_lshl_add_u32 v11, v8, 3, v11
    v_mul_u32_u24 v11, 2688, v11
    v_mul_u32_u24 v12, 0, v10
    v_add_u32 v11, v11, v12
    s_mul_i32 s7, s4, 56
    s_add_u32 s7, s7, 0
    v_add_u32 v11, s7, v11
    v_lshl_add_u32 v11, v7, 2, v11
    v_cmp_gt_u32 vcc, 14, v7
    v_mov_b32 v12, 0x7fffffff
    s_nop 1
    v_cndmask_b32 v11, v12, v11, vcc
    v_cmp_gt_u32 vcc, 896, v6
    s_and_saveexec_b64 s[60:61], vcc
    buffer_load_dword v16, v11, s[52:55], 0 offen offset:0
    buffer_load_dword v17, v11, s[52:55], 0 offen offset:2688
    v_add_u32 v11, 5376, v11
    buffer_load_dword v18, v11, s[52:55], 0 offen offset:0
    buffer_load_dword v19, v11, s[52:55], 0 offen offset:2688
    v_add_u32 v11, 5376, v11
    buffer_load_dword v20, v11, s[52:55], 0 offen offset:0
    buffer_load_dword v21, v11, s[52:55], 0 offen offset:2688
    v_add_u32 v11, 5376, v11
    buffer_load_dword v22, v11, s[52:55], 0 offen offset:0
    buffer_load_dword v23, v11, s[52:55], 0 offen offset:2688
    s_waitcnt vmcnt(0)
    v_and_b32 v13, 0xffff, v16
    v_lshl_or_b32 v24, v17, 16, v13
    v_lshrrev_b32 v13, 16, v16
    v_and_b32 v14, 0xffff0000, v17
    v_or_b32 v28, v13, v14
    v_and_b32 v13, 0xffff, v18
    v_lshl_or_b32 v25, v19, 16, v13
    v_lshrrev_b32 v13, 16, v18
    v_and_b32 v14, 0xffff0000, v19
    v_or_b32 v29, v13, v14
    v_and_b32 v13, 0xffff, v20
    v_lshl_or_b32 v26, v21, 16, v13
    v_lshrrev_b32 v13, 16, v20
    v_and_b32 v14, 0xffff0000, v21
    v_or_b32 v30, v13, v14
    v_and_b32 v13, 0xffff, v22
    v_lshl_or_b32 v27, v23, 16, v13
    v_lshrrev_b32 v13, 16, v22
    v_and_b32 v14, 0xffff0000, v23
    v_or_b32 v31, v13, v14
    v_mul_u32_u24 v12, 28672, v10
    v_lshl_add_u32 v12, v9, 10, v12
    v_lshl_add_u32 v12, v8, 9, v12
    v_lshl_add_u32 v12, v7, 5, v12
    ds_write_b128 v12, v[24:27]
    ds_write_b128 v12, v[28:31] offset:16
    s_or_b64 exec, exec, s[60:61]
    s_waitcnt lgkmcnt(0)
    s_barrier
    ds_read_b128 v[16:19], v2 offset:0
    s_waitcnt lgkmcnt(0)
    v_mfma_f32_32x32x16_bf16 v[96:111], v[16:19], v[128:131], v[96:111]
    s_nop 4
    ds_read_b128 v[16:19], v2 offset:1024
    s_waitcnt lgkmcnt(0)
    v_mfma_f32_32x32x16_bf16 v[96:111], v[16:19], v[132:135], v[96:111]
    s_nop 4
    ds_read_b128 v[16:19], v2 offset:2048
    s_waitcnt lgkmcnt(0)
    v_mfma_f32_32x32x16_bf16 v[96:111], v[16:19], v[136:139], v[96:111]
    s_nop 4
    ds_read_b128 v[16:19], v2 offset:3072
    s_waitcnt lgkmcnt(0)
    v_mfma_f32_32x32x16_bf16 v[96:111], v[16:19], v[140:143], v[96:111]
    s_nop 4
    ds_read_b128 v[16:19], v2 offset:4096
    s_waitcnt lgkmcnt(0)
    v_mfma_f32_32x32x16_bf16 v[96:111], v[16:19], v[144:147], v[96:111]
    s_nop 4
    ds_read_b128 v[16:19], v2 offset:5120
    s_waitcnt lgkmcnt(0)
    v_mfma_f32_32x32x16_bf16 v[96:111], v[16:19], v[148:151], v[96:111]
    s_nop 4
    ds_read_b128 v[16:19], v2 offset:6144
    s_waitcnt lgkmcnt(0)
    v_mfma_f32_32x32x16_bf16 v[96:111], v[16:19], v[152:155], v[96:111]
    s_nop 4
    ds_read_b128 v[16:19], v2 offset:7168
    s_waitcnt lgkmcnt(0)
    v_mfma_f32_32x32x16_bf16 v[96:111], v[16:19], v[156:159], v[96:111]
    s_nop 4
    ds_read_b128 v[16:19], v2 offset:8192
    s_waitcnt lgkmcnt(0)
    v_mfma_f32_32x32x16_bf16 v[96:111], v[16:19], v[160:163], v[96:111]
    s_nop 4
    ds_read_b128 v[16:19], v2 offset:9216
    s_waitcnt lgkmcnt(0)
    v_mfma_f32_32x32x16_bf16 v[96:111], v[16:19], v[164:167], v[96:111]
    s_nop 4
    ds_read_b128 v[16:19], v2 offset:10240
    s_waitcnt lgkmcnt(0)
    v_mfma_f32_32x32x16_bf16 v[96:111], v[16:19], v[168:171], v[96:111]
    s_nop 4
    ds_read_b128 v[16:19], v2 offset:11264
    s_waitcnt lgkmcnt(0)
    v_mfma_f32_32x32x16_bf16 v[96:111], v[16:19], v[172:175], v[96:111]
    s_nop 4
    ds_read_b128 v[16:19], v2 offset:12288
    s_waitcnt lgkmcnt(0)
    v_mfma_f32_32x32x16_bf16 v[96:111], v[16:19], v[176:179], v[96:111]
    s_nop 4
    ds_read_b128 v[16:19], v2 offset:13312
    s_waitcnt lgkmcnt(0)
    v_mfma_f32_32x32x16_bf16 v[96:111], v[16:19], v[180:183], v[96:111]
    s_nop 4
    ds_read_b128 v[16:19], v2 offset:14336
    s_waitcnt lgkmcnt(0)
    v_mfma_f32_32x32x16_bf16 v[96:111], v[16:19], v[184:187], v[96:111]
    s_nop 4
    ds_read_b128 v[16:19], v2 offset:15360
    s_waitcnt lgkmcnt(0)
    v_mfma_f32_32x32x16_bf16 v[96:111], v[16:19], v[188:191], v[96:111]
    s_nop 4
    ds_read_b128 v[16:19], v2 offset:16384
    s_waitcnt lgkmcnt(0)
    v_mfma_f32_32x32x16_bf16 v[96:111], v[16:19], v[192:195], v[96:111]
    s_nop 4
    ds_read_b128 v[16:19], v2 offset:17408
    s_waitcnt lgkmcnt(0)
    v_mfma_f32_32x32x16_bf16 v[96:111], v[16:19], v[196:199], v[96:111]
    s_nop 4
    ds_read_b128 v[16:19], v2 offset:18432
    s_waitcnt lgkmcnt(0)
    v_mfma_f32_32x32x16_bf16 v[96:111], v[16:19], v[200:203], v[96:111]
    s_nop 4
    ds_read_b128 v[16:19], v2 offset:19456
    s_waitcnt lgkmcnt(0)
    v_mfma_f32_32x32x16_bf16 v[96:111], v[16:19], v[204:207], v[96:111]
    s_nop 4
    ds_read_b128 v[16:19], v2 offset:20480
    s_waitcnt lgkmcnt(0)
    v_mfma_f32_32x32x16_bf16 v[96:111], v[16:19], v[208:211], v[96:111]
    s_nop 4
    ds_read_b128 v[16:19], v2 offset:21504
    s_waitcnt lgkmcnt(0)
    v_mfma_f32_32x32x16_bf16 v[96:111], v[16:19], v[212:215], v[96:111]
    s_nop 4
    ds_read_b128 v[16:19], v2 offset:22528
    s_waitcnt lgkmcnt(0)
    v_mfma_f32_32x32x16_bf16 v[96:111], v[16:19], v[216:219], v[96:111]
    s_nop 4
    ds_read_b128 v[16:19], v2 offset:23552
    s_waitcnt lgkmcnt(0)
    v_mfma_f32_32x32x16_bf16 v[96:111], v[16:19], v[220:223], v[96:111]
    s_nop 4
    ds_read_b128 v[16:19], v2 offset:24576
    s_waitcnt lgkmcnt(0)
    v_mfma_f32_32x32x16_bf16 v[96:111], v[16:19], v[224:227], v[96:111]
    s_nop 4
    ds_read_b128 v[16:19], v2 offset:25600
    s_waitcnt lgkmcnt(0)
    v_mfma_f32_32x32x16_bf16 v[96:111], v[16:19], v[228:231], v[96:111]
    s_nop 4
    ds_read_b128 v[16:19], v2 offset:26624
    s_waitcnt lgkmcnt(0)
    v_mfma_f32_32x32x16_bf16 v[96:111], v[16:19], v[232:235], v[96:111]
    s_nop 4
    ds_read_b128 v[16:19], v2 offset:27648
    s_waitcnt lgkmcnt(0)
    v_mfma_f32_32x32x16_bf16 v[96:111], v[16:19], v[236:239], v[96:111]
    s_nop 4
    s_nop 15
    v_lshlrev_b32 v5, 2, v4
    v_add_u32 v5, 0, v5
    s_mul_i32 s7, s4, 1568
    v_mul_u32_u24 v6, 56, v5
    v_add_u32 v6, s7, v6
    v_lshl_add_u32 v6, v3, 1, v6
    v_cmp_gt_u32 vcc, 28, v5
    v_cmp_gt_u32 s[60:61], 28, v3
    s_and_b64 vcc, vcc, s[60:61]
    v_mov_b32 v7, 0x7fffffff
    s_nop 1
    v_cndmask_b32 v6, v7, v6, vcc
    buffer_load_ushort v16, v6, s[56:59], 0 offen
    v_cmp_eq_u32 vcc, v5, v3
    v_mov_b32 v7, 0x3f80
    s_nop 1
    v_cndmask_b32 v112, 0, v7, vcc
    v_lshlrev_b32 v5, 2, v4
    v_add_u32 v5, 1, v5
    s_mul_i32 s7, s4, 1568
    v_mul_u32_u24 v6, 56, v5
    v_add_u32 v6, s7, v6
    v_lshl_add_u32 v6, v3, 1, v6
    v_cmp_gt_u32 vcc, 28, v5
    v_cmp_gt_u32 s[60:61], 28, v3
    s_and_b64 vcc, vcc, s[60:61]
    v_mov_b32 v7, 0x7fffffff
    s_nop 1
    v_cndmask_b32 v6, v7, v6, vcc
    buffer_load_ushort v17, v6, s[56:59], 0 offen
    v_cmp_eq_u32 vcc, v5, v3
    v_mov_b32 v7, 0x3f80
    s_nop 1
    v_cndmask_b32 v113, 0, v7, vcc
    v_lshlrev_b32 v5, 2, v4
    v_add_u32 v5, 2, v5
    s_mul_i32 s7, s4, 1568
    v_mul_u32_u24 v6, 56, v5
    v_add_u32 v6, s7, v6
    v_lshl_add_u32 v6, v3, 1, v6
    v_cmp_gt_u32 vcc, 28, v5
    v_cmp_gt_u32 s[60:61], 28, v3
    s_and_b64 vcc, vcc, s[60:61]
    v_mov_b32 v7, 0x7fffffff
    s_nop 1
    v_cndmask_b32 v6, v7, v6, vcc
    buffer_load_ushort v18, v6, s[56:59], 0 offen
    v_cmp_eq_u32 vcc, v5, v3
    v_mov_b32 v7, 0x3f80
    s_nop 1
    v_cndmask_b32 v114, 0, v7, vcc
    v_lshlrev_b32 v5, 2, v4
    v_add_u32 v5, 3, v5
    s_mul_i32 s7, s4, 1568
    v_mul_u32_u24 v6, 56, v5
    v_add_u32 v6, s7, v6
    v_lshl_add_u32 v6, v3, 1, v6
    v_cmp_gt_u32 vcc, 28, v5
    v_cmp_gt_u32 s[60:61], 28, v3
    s_and_b64 vcc, vcc, s[60:61]
    v_mov_b32 v7, 0x7fffffff
    s_nop 1
    v_cndmask_b32 v6, v7, v6, vcc
    buffer_load_ushort v19, v6, s[56:59], 0 offen
    v_cmp_eq_u32 vcc, v5, v3
    v_mov_b32 v7, 0x3f80
    s_nop 1
    v_cndmask_b32 v115, 0, v7, vcc
    v_lshlrev_b32 v5, 2, v4
    v_add_u32 v5, 8, v5
    s_mul_i32 s7, s4, 1568
    v_mul_u32_u24 v6, 56, v5
    v_add_u32 v6, s7, v6
    v_lshl_add_u32 v6, v3, 1, v6
    v_cmp_gt_u32 vcc, 28, v5
    v_cmp_gt_u32 s[60:61], 28, v3
    s_and_b64 vcc, vcc, s[60:61]
    v_mov_b32 v7, 0x7fffffff
    s_nop 1
    v_cndmask_b32 v6, v7, v6, vcc
    buffer_load_ushort v20, v6, s[56:59], 0 offen
    v_cmp_eq_u32 vcc, v5, v3
    v_mov_b32 v7, 0x3f80
    s_nop 1
    v_cndmask_b32 v116, 0, v7, vcc
    v_lshlrev_b32 v5, 2, v4
    v_add_u32 v5, 9, v5
    s_mul_i32 s7, s4, 1568
    v_mul_u32_u24 v6, 56, v5
    v_add_u32 v6, s7, v6
    v_lshl_add_u32 v6, v3, 1, v6
    v_cmp_gt_u32 vcc, 28, v5
    v_cmp_gt_u32 s[60:61], 28, v3
    s_and_b64 vcc, vcc, s[60:61]
    v_mov_b32 v7, 0x7fffffff
    s_nop 1
    v_cndmask_b32 v6, v7, v6, vcc
    buffer_load_ushort v21, v6, s[56:59], 0 offen
    v_cmp_eq_u32 vcc, v5, v3
    v_mov_b32 v7, 0x3f80
    s_nop 1
    v_cndmask_b32 v117, 0, v7, vcc
    v_lshlrev_b32 v5, 2, v4
    v_add_u32 v5, 10, v5
    s_mul_i32 s7, s4, 1568
    v_mul_u32_u24 v6, 56, v5
    v_add_u32 v6, s7, v6
    v_lshl_add_u32 v6, v3, 1, v6
    v_cmp_gt_u32 vcc, 28, v5
    v_cmp_gt_u32 s[60:61], 28, v3
    s_and_b64 vcc, vcc, s[60:61]
    v_mov_b32 v7, 0x7fffffff
    s_nop 1
    v_cndmask_b32 v6, v7, v6, vcc
    buffer_load_ushort v22, v6, s[56:59], 0 offen
    v_cmp_eq_u32 vcc, v5, v3
    v_mov_b32 v7, 0x3f80
    s_nop 1
    v_cndmask_b32 v118, 0, v7, vcc
    v_lshlrev_b32 v5, 2, v4
    v_add_u32 v5, 11, v5
    s_mul_i32 s7, s4, 1568
    v_mul_u32_u24 v6, 56, v5
    v_add_u32 v6, s7, v6
    v_lshl_add_u32 v6, v3, 1, v6
    v_cmp_gt_u32 vcc, 28, v5
    v_cmp_gt_u32 s[60:61], 28, v3
    s_and_b64 vcc, vcc, s[60:61]
    v_mov_b32 v7, 0x7fffffff
    s_nop 1
    v_cndmask_b32 v6, v7, v6, vcc
    buffer_load_ushort v23, v6, s[56:59], 0 offen
    v_cmp_eq_u32 vcc, v5, v3
    v_mov_b32 v7, 0x3f80
    s_nop 1
    v_cndmask_b32 v119, 0, v7, vcc
    s_waitcnt vmcnt(0)
    v_lshl_or_b32 v32, v17, 16, v16
    v_lshl_or_b32 v40, v113, 16, v112
    v_lshl_or_b32 v33, v19, 16, v18
    v_lshl_or_b32 v41, v115, 16, v114
    v_lshl_or_b32 v34, v21, 16, v20
    v_lshl_or_b32 v42, v117, 16, v116
    v_lshl_or_b32 v35, v23, 16, v22
    v_lshl_or_b32 v43, v119, 16, v118
    v_lshlrev_b32 v5, 2, v4
    v_add_u32 v5, 16, v5
    s_mul_i32 s7, s4, 1568
    v_mul_u32_u24 v6, 56, v5
    v_add_u32 v6, s7, v6
    v_lshl_add_u32 v6, v3, 1, v6
    v_cmp_gt_u32 vcc, 28, v5
    v_cmp_gt_u32 s[60:61], 28, v3
    s_and_b64 vcc, vcc, s[60:61]
    v_mov_b32 v7, 0x7fffffff
    s_nop 1
    v_cndmask_b32 v6, v7, v6, vcc
    buffer_load_ushort v16, v6, s[56:59], 0 offen
    v_cmp_eq_u32 vcc, v5, v3
    v_mov_b32 v7, 0x3f80
    s_nop 1
    v_cndmask_b32 v112, 0, v7, vcc
    v_lshlrev_b32 v5, 2, v4
    v_add_u32 v5, 17, v5
    s_mul_i32 s7, s4, 1568
    v_mul_u32_u24 v6, 56, v5
    v_add_u32 v6, s7, v6
    v_lshl_add_u32 v6, v3, 1, v6
    v_cmp_gt_u32 vcc, 28, v5
    v_cmp_gt_u32 s[60:61], 28, v3
    s_and_b64 vcc, vcc, s[60:61]
    v_mov_b32 v7, 0x7fffffff
    s_nop 1
    v_cndmask_b32 v6, v7, v6, vcc
    buffer_load_ushort v17, v6, s[56:59], 0 offen
    v_cmp_eq_u32 vcc, v5, v3
    v_mov_b32 v7, 0x3f80
    s_nop 1
    v_cndmask_b32 v113, 0, v7, vcc
    v_lshlrev_b32 v5, 2, v4
    v_add_u32 v5, 18, v5
    s_mul_i32 s7, s4, 1568
    v_mul_u32_u24 v6, 56, v5
    v_add_u32 v6, s7, v6
    v_lshl_add_u32 v6, v3, 1, v6
    v_cmp_gt_u32 vcc, 28, v5
    v_cmp_gt_u32 s[60:61], 28, v3
    s_and_b64 vcc, vcc, s[60:61]
    v_mov_b32 v7, 0x7fffffff
    s_nop 1
    v_cndmask_b32 v6, v7, v6, vcc
    buffer_load_ushort v18, v6, s[56:59], 0 offen
    v_cmp_eq_u32 vcc, v5, v3
    v_mov_b32 v7, 0x3f80
    s_nop 1
    v_cndmask_b32 v114, 0, v7, vcc
    v_lshlrev_b32 v5, 2, v4
    v_add_u32 v5, 19, v5
    s_mul_i32 s7, s4, 1568
    v_mul_u32_u24 v6, 56, v5
    v_add_u32 v6, s7, v6
    v_lshl_add_u32 v6, v3, 1, v6
    v_cmp_gt_u32 vcc, 28, v5
    v_cmp_gt_u32 s[60:61], 28, v3
    s_and_b64 vcc, vcc, s[60:61]
    v_mov_b32 v7, 0x7fffffff
    s_nop 1
    v_cndmask_b32 v6, v7, v6, vcc
    buffer_load_ushort v19, v6, s[56:59], 0 offen
    v_cmp_eq_u32 vcc, v5, v3
    v_mov_b32 v7, 0x3f80
    s_nop 1
    v_cndmask_b32 v115, 0, v7, vcc
    v_lshlrev_b32 v5, 2, v4
    v_add_u32 v5, 24, v5
    s_mul_i32 s7, s4, 1568
    v_mul_u32_u24 v6, 56, v5
    v_add_u32 v6, s7, v6
    v_lshl_add_u32 v6, v3, 1, v6
    v_cmp_gt_u32 vcc, 28, v5
    v_cmp_gt_u32 s[60:61], 28, v3
    s_and_b64 vcc, vcc, s[60:61]
    v_mov_b32 v7, 0x7fffffff
    s_nop 1
    v_cndmask_b32 v6, v7, v6, vcc
    buffer_load_ushort v20, v6, s[56:59], 0 offen
    v_cmp_eq_u32 vcc, v5, v3
    v_mov_b32 v7, 0x3f80
    s_nop 1
    v_cndmask_b32 v116, 0, v7, vcc
    v_lshlrev_b32 v5, 2, v4
    v_add_u32 v5, 25, v5
    s_mul_i32 s7, s4, 1568
    v_mul_u32_u24 v6, 56, v5
    v_add_u32 v6, s7, v6
    v_lshl_add_u32 v6, v3, 1, v6
    v_cmp_gt_u32 vcc, 28, v5
    v_cmp_gt_u32 s[60:61], 28, v3
    s_and_b64 vcc, vcc, s[60:61]
    v_mov_b32 v7, 0x7fffffff
    s_nop 1
    v_cndmask_b32 v6, v7, v6, vcc
    buffer_load_ushort v21, v6, s[56:59], 0 offen
    v_cmp_eq_u32 vcc, v5, v3
    v_mov_b32 v7, 0x3f80
    s_nop 1
    v_cndmask_b32 v117, 0, v7, vcc
    v_lshlrev_b32 v5, 2, v4
    v_add_u32 v5, 26, v5
    s_mul_i32 s7, s4, 1568
    v_mul_u32_u24 v6, 56, v5
    v_add_u32 v6, s7, v6
    v_lshl_add_u32 v6, v3, 1, v6
    v_cmp_gt_u32 vcc, 28, v5
    v_cmp_gt_u32 s[60:61], 28, v3
    s_and_b64 vcc, vcc, s[60:61]
    v_mov_b32 v7, 0x7fffffff
    s_nop 1
    v_cndmask_b32 v6, v7, v6, vcc
    buffer_load_ushort v22, v6, s[56:59], 0 offen
    v_cmp_eq_u32 vcc, v5, v3
    v_mov_b32 v7, 0x3f80
    s_nop 1
    v_cndmask_b32 v118, 0, v7, vcc
    v_lshlrev_b32 v5, 2, v4
    v_add_u32 v5, 27, v5
    s_mul_i32 s7, s4, 1568
    v_mul_u32_u24 v6, 56, v5
    v_add_u32 v6, s7, v6
    v_lshl_add_u32 v6, v3, 1, v6
    v_cmp_gt_u32 vcc, 28, v5
    v_cmp_gt_u32 s[60:61], 28, v3
    s_and_b64 vcc, vcc, s[60:61]
    v_mov_b32 v7, 0x7fffffff
    s_nop 1
    v_cndmask_b32 v6, v7, v6, vcc
    buffer_load_ushort v23, v6, s[56:59], 0 offen
    v_cmp_eq_u32 vcc, v5, v3
    v_mov_b32 v7, 0x3f80
    s_nop 1
    v_cndmask_b32 v119, 0, v7, vcc
    s_waitcnt vmcnt(0)
    v_lshl_or_b32 v36, v17, 16, v16
    v_lshl_or_b32 v44, v113, 16, v112
    v_lshl_or_b32 v37, v19, 16, v18
    v_lshl_or_b32 v45, v115, 16, v114
    v_lshl_or_b32 v38, v21, 16, v20
    v_lshl_or_b32 v46, v117, 16, v116
    v_lshl_or_b32 v39, v23, 16, v22
    v_lshl_or_b32 v47, v119, 16, v118
    v_cvt_pk_bf16_f32 v16, v96, v97
    v_cvt_pk_bf16_f32 v17, v98, v99
    v_cvt_pk_bf16_f32 v18, v100, v101
    v_cvt_pk_bf16_f32 v19, v102, v103
    v_cvt_pk_bf16_f32 v20, v104, v105
    v_cvt_pk_bf16_f32 v21, v106, v107
    v_cvt_pk_bf16_f32 v22, v108, v109
    v_cvt_pk_bf16_f32 v23, v110, v111
    s_nop 1
    v_mov_b32 v48, 0
    v_mov_b32 v49, 0
    v_mov_b32 v50, 0
    v_mov_b32 v51, 0
    v_mov_b32 v52, 0
    v_mov_b32 v53, 0
    v_mov_b32 v54, 0
    v_mov_b32 v55, 0
    v_mov_b32 v56, 0
    v_mov_b32 v57, 0
    v_mov_b32 v58, 0
    v_mov_b32 v59, 0
    v_mov_b32 v60, 0
    v_mov_b32 v61, 0
    v_mov_b32 v62, 0
    v_mov_b32 v63, 0
    s_nop 2
    v_mfma_f32_32x32x16_bf16 v[48:63], v[32:35], v[16:19], v[48:63]
    v_mfma_f32_32x32x16_bf16 v[48:63], v[36:39], v[20:23], v[48:63]
    s_nop 15
    v_cvt_pk_bf16_f32 v16, v48, v49
    v_lshlrev_b32 v48, 16, v16
    v_and_b32 v49, 0xffff0000, v16
    v_cvt_pk_bf16_f32 v16, v50, v51
    v_lshlrev_b32 v50, 16, v16
    v_and_b32 v51, 0xffff0000, v16
    v_cvt_pk_bf16_f32 v16, v52, v53
    v_lshlrev_b32 v52, 16, v16
    v_and_b32 v53, 0xffff0000, v16
    v_cvt_pk_bf16_f32 v16, v54, v55
    v_lshlrev_b32 v54, 16, v16
    v_and_b32 v55, 0xffff0000, v16
    v_cvt_pk_bf16_f32 v16, v56, v57
    v_lshlrev_b32 v56, 16, v16
    v_and_b32 v57, 0xffff0000, v16
    v_cvt_pk_bf16_f32 v16, v58, v59
    v_lshlrev_b32 v58, 16, v16
    v_and_b32 v59, 0xffff0000, v16
    v_cvt_pk_bf16_f32 v16, v60, v61
    v_lshlrev_b32 v60, 16, v16
    v_and_b32 v61, 0xffff0000, v16
    v_cvt_pk_bf16_f32 v16, v62, v63
    v_lshlrev_b32 v62, 16, v16
    v_and_b32 v63, 0xffff0000, v16
    v_cmp_eq_u32 s[62:63], 1, v4
    v_mov_b32 v16, v48
    v_mov_b32 v17, v48
    v_max_f32 v16, v16, v49
    v_min_f32 v17, v17, v49
    v_max_f32 v16, v16, v50
    v_min_f32 v17, v17, v50
    v_max_f32 v16, v16, v51
    v_min_f32 v17, v17, v51
    v_max_f32 v16, v16, v52
    v_min_f32 v17, v17, v52
    v_max_f32 v16, v16, v53
    v_min_f32 v17, v17, v53
    v_max_f32 v16, v16, v54
    v_min_f32 v17, v17, v54
    v_max_f32 v16, v16, v55
    v_min_f32 v17, v17, v55
    v_max_f32 v16, v16, v56
    v_min_f32 v17, v17, v56
    v_max_f32 v16, v16, v57
    v_min_f32 v17, v17, v57
    v_max_f32 v16, v16, v58
    v_min_f32 v17, v17, v58
    v_max_f32 v16, v16, v59
    v_min_f32 v17, v17, v59
    v_cndmask_b32 v18, v60, v48, s[62:63]
    v_max_f32 v16, v16, v18
    v_min_f32 v17, v17, v18
    v_cndmask_b32 v18, v61, v48, s[62:63]
    v_max_f32 v16, v16, v18
    v_min_f32 v17, v17, v18
    v_cndmask_b32 v18, v62, v48, s[62:63]
    v_max_f32 v16, v16, v18
    v_min_f32 v17, v17, v18
    v_cndmask_b32 v18, v63, v48, s[62:63]
    v_max_f32 v16, v16, v18
    v_min_f32 v17, v17, v18
    v_mov_b32 v18, v16
    v_mov_b32 v19, v17
    s_nop 1
    v_permlane32_swap_b32 v16, v18
    v_permlane32_swap_b32 v17, v19
    s_nop 1
    v_max_f32 v16, v16, v18
    v_min_f32 v17, v17, v19
    v_mov_b32 v20, 0
    v_sub_f32 v21, v48, v16
    v_mul_f32 v21, 0x3fb8aa3b, v21
    v_exp_f32 v112, v21
    s_nop 0
    v_add_f32 v20, v20, v112
    v_sub_f32 v21, v49, v16
    v_mul_f32 v21, 0x3fb8aa3b, v21
    v_exp_f32 v113, v21
    s_nop 0
    v_add_f32 v20, v20, v113
    v_sub_f32 v21, v50, v16
    v_mul_f32 v21, 0x3fb8aa3b, v21
    v_exp_f32 v114, v21
    s_nop 0
    v_add_f32 v20, v20, v114
    v_sub_f32 v21, v51, v16
    v_mul_f32 v21, 0x3fb8aa3b, v21
    v_exp_f32 v115, v21
    s_nop 0
    v_add_f32 v20, v20, v115
    v_sub_f32 v21, v52, v16
    v_mul_f32 v21, 0x3fb8aa3b, v21
    v_exp_f32 v116, v21
    s_nop 0
    v_add_f32 v20, v20, v116
    v_sub_f32 v21, v53, v16
    v_mul_f32 v21, 0x3fb8aa3b, v21
    v_exp_f32 v117, v21
    s_nop 0
    v_add_f32 v20, v20, v117
    v_sub_f32 v21, v54, v16
    v_mul_f32 v21, 0x3fb8aa3b, v21
    v_exp_f32 v118, v21
    s_nop 0
    v_add_f32 v20, v20, v118
    v_sub_f32 v21, v55, v16
    v_mul_f32 v21, 0x3fb8aa3b, v21
    v_exp_f32 v119, v21
    s_nop 0
    v_add_f32 v20, v20, v119
    v_sub_f32 v21, v56, v16
    v_mul_f32 v21, 0x3fb8aa3b, v21
    v_exp_f32 v120, v21
    s_nop 0
    v_add_f32 v20, v20, v120
    v_sub_f32 v21, v57, v16
    v_mul_f32 v21, 0x3fb8aa3b, v21
    v_exp_f32 v121, v21
    s_nop 0
    v_add_f32 v20, v20, v121
    v_sub_f32 v21, v58, v16
    v_mul_f32 v21, 0x3fb8aa3b, v21
    v_exp_f32 v122, v21
    s_nop 0
    v_add_f32 v20, v20, v122
    v_sub_f32 v21, v59, v16
    v_mul_f32 v21, 0x3fb8aa3b, v21
    v_exp_f32 v123, v21
    s_nop 0
    v_add_f32 v20, v20, v123
    v_sub_f32 v21, v60, v16
    v_mul_f32 v21, 0x3fb8aa3b, v21
    v_exp_f32 v124, v21
    s_nop 0
    v_cndmask_b32 v124, v124, 0, s[62:63]
    v_add_f32 v20, v20, v124
    v_sub_f32 v21, v61, v16
    v_mul_f32 v21, 0x3fb8aa3b, v21
    v_exp_f32 v125, v21
    s_nop 0
    v_cndmask_b32 v125, v125, 0, s[62:63]
    v_add_f32 v20, v20, v125
    v_sub_f32 v21, v62, v16
    v_mul_f32 v21, 0x3fb8aa3b, v21
    v_exp_f32 v126, v21
    s_nop 0
    v_cndmask_b32 v126, v126, 0, s[62:63]
    v_add_f32 v20, v20, v126
    v_sub_f32 v21, v63, v16
    v_mul_f32 v21, 0x3fb8aa3b, v21
    v_exp_f32 v127, v21
    s_nop 0
    v_cndmask_b32 v127, v127, 0, s[62:63]
    v_add_f32 v20, v20, v127
    v_mov_b32 v21, v20
    s_nop 1
    v_permlane32_swap_b32 v20, v21
    s_nop 1
    v_add_f32 v20, v20, v21
    v_rcp_f32 v20, v20
    s_nop 0
    v_mul_f32 v112, v20, v112
    v_mul_f32 v113, v20, v113
    v_mul_f32 v114, v20, v114
    v_mul_f32 v115, v20, v115
    v_mul_f32 v116, v20, v116
    v_mul_f32 v117, v20, v117
    v_mul_f32 v118, v20, v118
    v_mul_f32 v119, v20, v119
    v_mul_f32 v120, v20, v120
    v_mul_f32 v121, v20, v121
    v_mul_f32 v122, v20, v122
    v_mul_f32 v123, v20, v123
    v_mul_f32 v124, v20, v124
    v_mul_f32 v125, v20, v125
    v_mul_f32 v126, v20, v126
    v_mul_f32 v127, v20, v127
    v_cvt_pk_bf16_f32 v24, v112, v113
    v_cvt_pk_bf16_f32 v25, v114, v115
    v_cvt_pk_bf16_f32 v26, v116, v117
    v_cvt_pk_bf16_f32 v27, v118, v119
    v_cvt_pk_bf16_f32 v28, v120, v121
    v_cvt_pk_bf16_f32 v29, v122, v123
    v_cvt_pk_bf16_f32 v30, v124, v125
    v_cvt_pk_bf16_f32 v31, v126, v127
    v_mov_b32 v20, 0
    v_sub_f32 v21, v17, v48
    v_mul_f32 v21, 0x3fb8aa3b, v21
    v_exp_f32 v96, v21
    s_nop 0
    v_add_f32 v20, v20, v96
    v_sub_f32 v21, v17, v49
    v_mul_f32 v21, 0x3fb8aa3b, v21
    v_exp_f32 v97, v21
    s_nop 0
    v_add_f32 v20, v20, v97
    v_sub_f32 v21, v17, v50
    v_mul_f32 v21, 0x3fb8aa3b, v21
    v_exp_f32 v98, v21
    s_nop 0
    v_add_f32 v20, v20, v98
    v_sub_f32 v21, v17, v51
    v_mul_f32 v21, 0x3fb8aa3b, v21
    v_exp_f32 v99, v21
    s_nop 0
    v_add_f32 v20, v20, v99
    v_sub_f32 v21, v17, v52
    v_mul_f32 v21, 0x3fb8aa3b, v21
    v_exp_f32 v100, v21
    s_nop 0
    v_add_f32 v20, v20, v100
    v_sub_f32 v21, v17, v53
    v_mul_f32 v21, 0x3fb8aa3b, v21
    v_exp_f32 v101, v21
    s_nop 0
    v_add_f32 v20, v20, v101
    v_sub_f32 v21, v17, v54
    v_mul_f32 v21, 0x3fb8aa3b, v21
    v_exp_f32 v102, v21
    s_nop 0
    v_add_f32 v20, v20, v102
    v_sub_f32 v21, v17, v55
    v_mul_f32 v21, 0x3fb8aa3b, v21
    v_exp_f32 v103, v21
    s_nop 0
    v_add_f32 v20, v20, v103
    v_sub_f32 v21, v17, v56
    v_mul_f32 v21, 0x3fb8aa3b, v21
    v_exp_f32 v104, v21
    s_nop 0
    v_add_f32 v20, v20, v104
    v_sub_f32 v21, v17, v57
    v_mul_f32 v21, 0x3fb8aa3b, v21
    v_exp_f32 v105, v21
    s_nop 0
    v_add_f32 v20, v20, v105
    v_sub_f32 v21, v17, v58
    v_mul_f32 v21, 0x3fb8aa3b, v21
    v_exp_f32 v106, v21
    s_nop 0
    v_add_f32 v20, v20, v106
    v_sub_f32 v21, v17, v59
    v_mul_f32 v21, 0x3fb8aa3b, v21
    v_exp_f32 v107, v21
    s_nop 0
    v_add_f32 v20, v20, v107
    v_sub_f32 v21, v17, v60
    v_mul_f32 v21, 0x3fb8aa3b, v21
    v_exp_f32 v108, v21
    s_nop 0
    v_cndmask_b32 v108, v108, 0, s[62:63]
    v_add_f32 v20, v20, v108
    v_sub_f32 v21, v17, v61
    v_mul_f32 v21, 0x3fb8aa3b, v21
    v_exp_f32 v109, v21
    s_nop 0
    v_cndmask_b32 v109, v109, 0, s[62:63]
    v_add_f32 v20, v20, v109
    v_sub_f32 v21, v17, v62
    v_mul_f32 v21, 0x3fb8aa3b, v21
    v_exp_f32 v110, v21
    s_nop 0
    v_cndmask_b32 v110, v110, 0, s[62:63]
    v_add_f32 v20, v20, v110
    v_sub_f32 v21, v17, v63
    v_mul_f32 v21, 0x3fb8aa3b, v21
    v_exp_f32 v111, v21
    s_nop 0
    v_cndmask_b32 v111, v111, 0, s[62:63]
    v_add_f32 v20, v20, v111
    v_mov_b32 v21, v20
    s_nop 1
    v_permlane32_swap_b32 v20, v21
    s_nop 1
    v_add_f32 v20, v20, v21
    v_rcp_f32 v20, v20
    s_nop 0
    v_mul_f32 v96, v20, v96
    v_mul_f32 v97, v20, v97
    v_mul_f32 v98, v20, v98
    v_mul_f32 v99, v20, v99
    v_mul_f32 v100, v20, v100
    v_mul_f32 v101, v20, v101
    v_mul_f32 v102, v20, v102
    v_mul_f32 v103, v20, v103
    v_mul_f32 v104, v20, v104
    v_mul_f32 v105, v20, v105
    v_mul_f32 v106, v20, v106
    v_mul_f32 v107, v20, v107
    v_mul_f32 v108, v20, v108
    v_mul_f32 v109, v20, v109
    v_mul_f32 v110, v20, v110
    v_mul_f32 v111, v20, v111
    v_cvt_pk_bf16_f32 v8, v96, v97
    v_cvt_pk_bf16_f32 v9, v98, v99
    v_cvt_pk_bf16_f32 v10, v100, v101
    v_cvt_pk_bf16_f32 v11, v102, v103
    v_cvt_pk_bf16_f32 v12, v104, v105
    v_cvt_pk_bf16_f32 v13, v106, v107
    v_cvt_pk_bf16_f32 v14, v108, v109
    v_cvt_pk_bf16_f32 v15, v110, v111
    s_lshr_b32 s7, s6, 5
    s_lshl_b32 s7, s7, 4
    s_add_u32 s7, s7, s4
    s_lshl_b32 s7, s7, 12
    buffer_store_dwordx4 v[24:27], v2, s[44:47], s7 offen offset:0
    buffer_store_dwordx4 v[28:31], v2, s[44:47], s7 offen offset:1024
    buffer_store_dwordx4 v[8:11], v2, s[44:47], s7 offen offset:2048
    buffer_store_dwordx4 v[12:15], v2, s[44:47], s7 offen offset:3072
    s_nop 2
    v_cvt_pk_bf16_f32 v16, v64, v65
    v_cvt_pk_bf16_f32 v17, v66, v67
    v_cvt_pk_bf16_f32 v18, v68, v69
    v_cvt_pk_bf16_f32 v19, v70, v71
    v_cvt_pk_bf16_f32 v20, v72, v73
    v_cvt_pk_bf16_f32 v21, v74, v75
    v_cvt_pk_bf16_f32 v22, v76, v77
    v_cvt_pk_bf16_f32 v23, v78, v79
    s_nop 1
    v_mov_b32 v48, 0
    v_mov_b32 v49, 0
    v_mov_b32 v50, 0
    v_mov_b32 v51, 0
    v_mov_b32 v52, 0
    v_mov_b32 v53, 0
    v_mov_b32 v54, 0
    v_mov_b32 v55, 0
    v_mov_b32 v56, 0
    v_mov_b32 v57, 0
    v_mov_b32 v58, 0
    v_mov_b32 v59, 0
    v_mov_b32 v60, 0
    v_mov_b32 v61, 0
    v_mov_b32 v62, 0
    v_mov_b32 v63, 0
    s_nop 2
    v_mfma_f32_32x32x16_bf16 v[48:63], v[32:35], v[16:19], v[48:63]
    v_mfma_f32_32x32x16_bf16 v[48:63], v[36:39], v[20:23], v[48:63]
    s_nop 15
    v_cvt_pk_bf16_f32 v16, v48, v49
    v_lshlrev_b32 v48, 16, v16
    v_and_b32 v49, 0xffff0000, v16
    v_cvt_pk_bf16_f32 v16, v50, v51
    v_lshlrev_b32 v50, 16, v16
    v_and_b32 v51, 0xffff0000, v16
    v_cvt_pk_bf16_f32 v16, v52, v53
    v_lshlrev_b32 v52, 16, v16
    v_and_b32 v53, 0xffff0000, v16
    v_cvt_pk_bf16_f32 v16, v54, v55
    v_lshlrev_b32 v54, 16, v16
    v_and_b32 v55, 0xffff0000, v16
    v_cvt_pk_bf16_f32 v16, v56, v57
    v_lshlrev_b32 v56, 16, v16
    v_and_b32 v57, 0xffff0000, v16
    v_cvt_pk_bf16_f32 v16, v58, v59
    v_lshlrev_b32 v58, 16, v16
    v_and_b32 v59, 0xffff0000, v16
    v_cvt_pk_bf16_f32 v16, v60, v61
    v_lshlrev_b32 v60, 16, v16
    v_and_b32 v61, 0xffff0000, v16
    v_cvt_pk_bf16_f32 v16, v62, v63
    v_lshlrev_b32 v62, 16, v16
    v_and_b32 v63, 0xffff0000, v16
    v_cmp_eq_u32 s[62:63], 1, v4
    v_mov_b32 v16, v48
    v_mov_b32 v17, v48
    v_max_f32 v16, v16, v49
    v_min_f32 v17, v17, v49
    v_max_f32 v16, v16, v50
    v_min_f32 v17, v17, v50
    v_max_f32 v16, v16, v51
    v_min_f32 v17, v17, v51
    v_max_f32 v16, v16, v52
    v_min_f32 v17, v17, v52
    v_max_f32 v16, v16, v53
    v_min_f32 v17, v17, v53
    v_max_f32 v16, v16, v54
    v_min_f32 v17, v17, v54
    v_max_f32 v16, v16, v55
    v_min_f32 v17, v17, v55
    v_max_f32 v16, v16, v56
    v_min_f32 v17, v17, v56
    v_max_f32 v16, v16, v57
    v_min_f32 v17, v17, v57
    v_max_f32 v16, v16, v58
    v_min_f32 v17, v17, v58
    v_max_f32 v16, v16, v59
    v_min_f32 v17, v17, v59
    v_cndmask_b32 v18, v60, v48, s[62:63]
    v_max_f32 v16, v16, v18
    v_min_f32 v17, v17, v18
    v_cndmask_b32 v18, v61, v48, s[62:63]
    v_max_f32 v16, v16, v18
    v_min_f32 v17, v17, v18
    v_cndmask_b32 v18, v62, v48, s[62:63]
    v_max_f32 v16, v16, v18
    v_min_f32 v17, v17, v18
    v_cndmask_b32 v18, v63, v48, s[62:63]
    v_max_f32 v16, v16, v18
    v_min_f32 v17, v17, v18
    v_mov_b32 v18, v16
    v_mov_b32 v19, v17
    s_nop 1
    v_permlane32_swap_b32 v16, v18
    v_permlane32_swap_b32 v17, v19
    s_nop 1
    v_max_f32 v16, v16, v18
    v_min_f32 v17, v17, v19
    v_mov_b32 v20, 0
    v_sub_f32 v21, v48, v16
    v_mul_f32 v21, 0x3fb8aa3b, v21
    v_exp_f32 v112, v21
    s_nop 0
    v_add_f32 v20, v20, v112
    v_sub_f32 v21, v49, v16
    v_mul_f32 v21, 0x3fb8aa3b, v21
    v_exp_f32 v113, v21
    s_nop 0
    v_add_f32 v20, v20, v113
    v_sub_f32 v21, v50, v16
    v_mul_f32 v21, 0x3fb8aa3b, v21
    v_exp_f32 v114, v21
    s_nop 0
    v_add_f32 v20, v20, v114
    v_sub_f32 v21, v51, v16
    v_mul_f32 v21, 0x3fb8aa3b, v21
    v_exp_f32 v115, v21
    s_nop 0
    v_add_f32 v20, v20, v115
    v_sub_f32 v21, v52, v16
    v_mul_f32 v21, 0x3fb8aa3b, v21
    v_exp_f32 v116, v21
    s_nop 0
    v_add_f32 v20, v20, v116
    v_sub_f32 v21, v53, v16
    v_mul_f32 v21, 0x3fb8aa3b, v21
    v_exp_f32 v117, v21
    s_nop 0
    v_add_f32 v20, v20, v117
    v_sub_f32 v21, v54, v16
    v_mul_f32 v21, 0x3fb8aa3b, v21
    v_exp_f32 v118, v21
    s_nop 0
    v_add_f32 v20, v20, v118
    v_sub_f32 v21, v55, v16
    v_mul_f32 v21, 0x3fb8aa3b, v21
    v_exp_f32 v119, v21
    s_nop 0
    v_add_f32 v20, v20, v119
    v_sub_f32 v21, v56, v16
    v_mul_f32 v21, 0x3fb8aa3b, v21
    v_exp_f32 v120, v21
    s_nop 0
    v_add_f32 v20, v20, v120
    v_sub_f32 v21, v57, v16
    v_mul_f32 v21, 0x3fb8aa3b, v21
    v_exp_f32 v121, v21
    s_nop 0
    v_add_f32 v20, v20, v121
    v_sub_f32 v21, v58, v16
    v_mul_f32 v21, 0x3fb8aa3b, v21
    v_exp_f32 v122, v21
    s_nop 0
    v_add_f32 v20, v20, v122
    v_sub_f32 v21, v59, v16
    v_mul_f32 v21, 0x3fb8aa3b, v21
    v_exp_f32 v123, v21
    s_nop 0
    v_add_f32 v20, v20, v123
    v_sub_f32 v21, v60, v16
    v_mul_f32 v21, 0x3fb8aa3b, v21
    v_exp_f32 v124, v21
    s_nop 0
    v_cndmask_b32 v124, v124, 0, s[62:63]
    v_add_f32 v20, v20, v124
    v_sub_f32 v21, v61, v16
    v_mul_f32 v21, 0x3fb8aa3b, v21
    v_exp_f32 v125, v21
    s_nop 0
    v_cndmask_b32 v125, v125, 0, s[62:63]
    v_add_f32 v20, v20, v125
    v_sub_f32 v21, v62, v16
    v_mul_f32 v21, 0x3fb8aa3b, v21
    v_exp_f32 v126, v21
    s_nop 0
    v_cndmask_b32 v126, v126, 0, s[62:63]
    v_add_f32 v20, v20, v126
    v_sub_f32 v21, v63, v16
    v_mul_f32 v21, 0x3fb8aa3b, v21
    v_exp_f32 v127, v21
    s_nop 0
    v_cndmask_b32 v127, v127, 0, s[62:63]
    v_add_f32 v20, v20, v127
    v_mov_b32 v21, v20
    s_nop 1
    v_permlane32_swap_b32 v20, v21
    s_nop 1
    v_add_f32 v20, v20, v21
    v_rcp_f32 v20, v20
    s_nop 0
    v_mul_f32 v112, v20, v112
    v_mul_f32 v113, v20, v113
    v_mul_f32 v114, v20, v114
    v_mul_f32 v115, v20, v115
    v_mul_f32 v116, v20, v116
    v_mul_f32 v117, v20, v117
    v_mul_f32 v118, v20, v118
    v_mul_f32 v119, v20, v119
    v_mul_f32 v120, v20, v120
    v_mul_f32 v121, v20, v121
    v_mul_f32 v122, v20, v122
    v_mul_f32 v123, v20, v123
    v_mul_f32 v124, v20, v124
    v_mul_f32 v125, v20, v125
    v_mul_f32 v126, v20, v126
    v_mul_f32 v127, v20, v127
    v_cvt_pk_bf16_f32 v24, v112, v113
    v_cvt_pk_bf16_f32 v25, v114, v115
    v_cvt_pk_bf16_f32 v26, v116, v117
    v_cvt_pk_bf16_f32 v27, v118, v119
    v_cvt_pk_bf16_f32 v28, v120, v121
    v_cvt_pk_bf16_f32 v29, v122, v123
    v_cvt_pk_bf16_f32 v30, v124, v125
    v_cvt_pk_bf16_f32 v31, v126, v127
    v_mov_b32 v20, 0
    v_sub_f32 v21, v17, v48
    v_mul_f32 v21, 0x3fb8aa3b, v21
    v_exp_f32 v64, v21
    s_nop 0
    v_add_f32 v20, v20, v64
    v_sub_f32 v21, v17, v49
    v_mul_f32 v21, 0x3fb8aa3b, v21
    v_exp_f32 v65, v21
    s_nop 0
    v_add_f32 v20, v20, v65
    v_sub_f32 v21, v17, v50
    v_mul_f32 v21, 0x3fb8aa3b, v21
    v_exp_f32 v66, v21
    s_nop 0
    v_add_f32 v20, v20, v66
    v_sub_f32 v21, v17, v51
    v_mul_f32 v21, 0x3fb8aa3b, v21
    v_exp_f32 v67, v21
    s_nop 0
    v_add_f32 v20, v20, v67
    v_sub_f32 v21, v17, v52
    v_mul_f32 v21, 0x3fb8aa3b, v21
    v_exp_f32 v68, v21
    s_nop 0
    v_add_f32 v20, v20, v68
    v_sub_f32 v21, v17, v53
    v_mul_f32 v21, 0x3fb8aa3b, v21
    v_exp_f32 v69, v21
    s_nop 0
    v_add_f32 v20, v20, v69
    v_sub_f32 v21, v17, v54
    v_mul_f32 v21, 0x3fb8aa3b, v21
    v_exp_f32 v70, v21
    s_nop 0
    v_add_f32 v20, v20, v70
    v_sub_f32 v21, v17, v55
    v_mul_f32 v21, 0x3fb8aa3b, v21
    v_exp_f32 v71, v21
    s_nop 0
    v_add_f32 v20, v20, v71
    v_sub_f32 v21, v17, v56
    v_mul_f32 v21, 0x3fb8aa3b, v21
    v_exp_f32 v72, v21
    s_nop 0
    v_add_f32 v20, v20, v72
    v_sub_f32 v21, v17, v57
    v_mul_f32 v21, 0x3fb8aa3b, v21
    v_exp_f32 v73, v21
    s_nop 0
    v_add_f32 v20, v20, v73
    v_sub_f32 v21, v17, v58
    v_mul_f32 v21, 0x3fb8aa3b, v21
    v_exp_f32 v74, v21
    s_nop 0
    v_add_f32 v20, v20, v74
    v_sub_f32 v21, v17, v59
    v_mul_f32 v21, 0x3fb8aa3b, v21
    v_exp_f32 v75, v21
    s_nop 0
    v_add_f32 v20, v20, v75
    v_sub_f32 v21, v17, v60
    v_mul_f32 v21, 0x3fb8aa3b, v21
    v_exp_f32 v76, v21
    s_nop 0
    v_cndmask_b32 v76, v76, 0, s[62:63]
    v_add_f32 v20, v20, v76
    v_sub_f32 v21, v17, v61
    v_mul_f32 v21, 0x3fb8aa3b, v21
    v_exp_f32 v77, v21
    s_nop 0
    v_cndmask_b32 v77, v77, 0, s[62:63]
    v_add_f32 v20, v20, v77
    v_sub_f32 v21, v17, v62
    v_mul_f32 v21, 0x3fb8aa3b, v21
    v_exp_f32 v78, v21
    s_nop 0
    v_cndmask_b32 v78, v78, 0, s[62:63]
    v_add_f32 v20, v20, v78
    v_sub_f32 v21, v17, v63
    v_mul_f32 v21, 0x3fb8aa3b, v21
    v_exp_f32 v79, v21
    s_nop 0
    v_cndmask_b32 v79, v79, 0, s[62:63]
    v_add_f32 v20, v20, v79
    v_mov_b32 v21, v20
    s_nop 1
    v_permlane32_swap_b32 v20, v21
    s_nop 1
    v_add_f32 v20, v20, v21
    v_rcp_f32 v20, v20
    s_nop 0
    v_mul_f32 v64, v20, v64
    v_mul_f32 v65, v20, v65
    v_mul_f32 v66, v20, v66
    v_mul_f32 v67, v20, v67
    v_mul_f32 v68, v20, v68
    v_mul_f32 v69, v20, v69
    v_mul_f32 v70, v20, v70
    v_mul_f32 v71, v20, v71
    v_mul_f32 v72, v20, v72
    v_mul_f32 v73, v20, v73
    v_mul_f32 v74, v20, v74
    v_mul_f32 v75, v20, v75
    v_mul_f32 v76, v20, v76
    v_mul_f32 v77, v20, v77
    v_mul_f32 v78, v20, v78
    v_mul_f32 v79, v20, v79
    v_cvt_pk_bf16_f32 v8, v64, v65
    v_cvt_pk_bf16_f32 v9, v66, v67
    v_cvt_pk_bf16_f32 v10, v68, v69
    v_cvt_pk_bf16_f32 v11, v70, v71
    v_cvt_pk_bf16_f32 v12, v72, v73
    v_cvt_pk_bf16_f32 v13, v74, v75
    v_cvt_pk_bf16_f32 v14, v76, v77
    v_cvt_pk_bf16_f32 v15, v78, v79
    v_cmp_eq_u32 vcc, 28, v3
    s_nop 1
    v_cndmask_b32 v80, v80, 1.0, vcc
    v_cndmask_b32 v81, v81, 1.0, vcc
    v_cndmask_b32 v82, v82, 1.0, vcc
    v_cndmask_b32 v83, v83, 1.0, vcc
    v_cndmask_b32 v84, v84, 1.0, vcc
    v_cndmask_b32 v85, v85, 1.0, vcc
    v_cndmask_b32 v86, v86, 1.0, vcc
    v_cndmask_b32 v87, v87, 1.0, vcc
    v_cndmask_b32 v88, v88, 1.0, vcc
    v_cndmask_b32 v89, v89, 1.0, vcc
    v_cndmask_b32 v90, v90, 1.0, vcc
    v_cndmask_b32 v91, v91, 1.0, vcc
    v_cndmask_b32 v92, v92, 1.0, vcc
    v_cndmask_b32 v93, v93, 1.0, vcc
    v_cndmask_b32 v94, v94, 1.0, vcc
    v_cndmask_b32 v95, v95, 1.0, vcc
    v_cvt_pk_bf16_f32 v64, v80, v81
    v_cvt_pk_bf16_f32 v65, v82, v83
    v_cvt_pk_bf16_f32 v66, v84, v85
    v_cvt_pk_bf16_f32 v67, v86, v87
    v_cvt_pk_bf16_f32 v68, v88, v89
    v_cvt_pk_bf16_f32 v69, v90, v91
    v_cvt_pk_bf16_f32 v70, v92, v93
    v_cvt_pk_bf16_f32 v71, v94, v95
    v_mov_b32 v48, 0
    v_mov_b32 v96, 0
    v_mov_b32 v49, 0
    v_mov_b32 v97, 0
    v_mov_b32 v50, 0
    v_mov_b32 v98, 0
    v_mov_b32 v51, 0
    v_mov_b32 v99, 0
    v_mov_b32 v52, 0
    v_mov_b32 v100, 0
    v_mov_b32 v53, 0
    v_mov_b32 v101, 0
    v_mov_b32 v54, 0
    v_mov_b32 v102, 0
    v_mov_b32 v55, 0
    v_mov_b32 v103, 0
    v_mov_b32 v56, 0
    v_mov_b32 v104, 0
    v_mov_b32 v57, 0
    v_mov_b32 v105, 0
    v_mov_b32 v58, 0
    v_mov_b32 v106, 0
    v_mov_b32 v59, 0
    v_mov_b32 v107, 0
    v_mov_b32 v60, 0
    v_mov_b32 v108, 0
    v_mov_b32 v61, 0
    v_mov_b32 v109, 0
    v_mov_b32 v62, 0
    v_mov_b32 v110, 0
    v_mov_b32 v63, 0
    v_mov_b32 v111, 0
    s_nop 2
    v_mfma_f32_32x32x16_bf16 v[48:63], v[24:27], v[40:43], v[48:63]
    v_mfma_f32_32x32x16_bf16 v[48:63], v[28:31], v[44:47], v[48:63]
    s_nop 15
    v_cvt_pk_bf16_f32 v16, v48, v49
    v_cvt_pk_bf16_f32 v17, v50, v51
    v_cvt_pk_bf16_f32 v18, v52, v53
    v_cvt_pk_bf16_f32 v19, v54, v55
    v_cvt_pk_bf16_f32 v20, v56, v57
    v_cvt_pk_bf16_f32 v21, v58, v59
    v_cvt_pk_bf16_f32 v22, v60, v61
    v_cvt_pk_bf16_f32 v23, v62, v63
    s_nop 2
    v_mfma_f32_32x32x16_bf16 v[96:111], v[16:19], v[64:67], v[96:111]
    v_mfma_f32_32x32x16_bf16 v[96:111], v[20:23], v[68:71], v[96:111]
    s_nop 15
    v_mov_b32 v48, 0
    v_mov_b32 v112, 0
    v_mov_b32 v49, 0
    v_mov_b32 v113, 0
    v_mov_b32 v50, 0
    v_mov_b32 v114, 0
    v_mov_b32 v51, 0
    v_mov_b32 v115, 0
    v_mov_b32 v52, 0
    v_mov_b32 v116, 0
    v_mov_b32 v53, 0
    v_mov_b32 v117, 0
    v_mov_b32 v54, 0
    v_mov_b32 v118, 0
    v_mov_b32 v55, 0
    v_mov_b32 v119, 0
    v_mov_b32 v56, 0
    v_mov_b32 v120, 0
    v_mov_b32 v57, 0
    v_mov_b32 v121, 0
    v_mov_b32 v58, 0
    v_mov_b32 v122, 0
    v_mov_b32 v59, 0
    v_mov_b32 v123, 0
    v_mov_b32 v60, 0
    v_mov_b32 v124, 0
    v_mov_b32 v61, 0
    v_mov_b32 v125, 0
    v_mov_b32 v62, 0
    v_mov_b32 v126, 0
    v_mov_b32 v63, 0
    v_mov_b32 v127, 0
    s_nop 2
    v_mfma_f32_32x32x16_bf16 v[48:63], v[8:11], v[40:43], v[48:63]
    v_mfma_f32_32x32x16_bf16 v[48:63], v[12:15], v[44:47], v[48:63]
    s_nop 15
    v_cvt_pk_bf16_f32 v16, v48, v49
    v_cvt_pk_bf16_f32 v17, v50, v51
    v_cvt_pk_bf16_f32 v18, v52, v53
    v_cvt_pk_bf16_f32 v19, v54, v55
    v_cvt_pk_bf16_f32 v20, v56, v57
    v_cvt_pk_bf16_f32 v21, v58, v59
    v_cvt_pk_bf16_f32 v22, v60, v61
    v_cvt_pk_bf16_f32 v23, v62, v63
    s_nop 2
    v_mfma_f32_32x32x16_bf16 v[112:127], v[16:19], v[64:67], v[112:127]
    v_mfma_f32_32x32x16_bf16 v[112:127], v[20:23], v[68:71], v[112:127]
    s_nop 15
    s_barrier
    s_lshl_b32 s7, s3, 13
    v_lshl_add_u32 v5, v1, 2, s7
    ds_write_b32 v5, v96 offset:0
    ds_write_b32 v5, v97 offset:256
    ds_write_b32 v5, v98 offset:512
    ds_write_b32 v5, v99 offset:768
    ds_write_b32 v5, v100 offset:1024
    ds_write_b32 v5, v101 offset:1280
    ds_write_b32 v5, v102 offset:1536
    ds_write_b32 v5, v103 offset:1792
    ds_write_b32 v5, v104 offset:2048
    ds_write_b32 v5, v105 offset:2304
    ds_write_b32 v5, v106 offset:2560
    ds_write_b32 v5, v107 offset:2816
    ds_write_b32 v5, v108 offset:3072
    ds_write_b32 v5, v109 offset:3328
    ds_write_b32 v5, v110 offset:3584
    ds_write_b32 v5, v111 offset:3840
    ds_write_b32 v5, v112 offset:4096
    ds_write_b32 v5, v113 offset:4352
    ds_write_b32 v5, v114 offset:4608
    ds_write_b32 v5, v115 offset:4864
    ds_write_b32 v5, v116 offset:5120
    ds_write_b32 v5, v117 offset:5376
    ds_write_b32 v5, v118 offset:5632
    ds_write_b32 v5, v119 offset:5888
    ds_write_b32 v5, v120 offset:6144
    ds_write_b32 v5, v121 offset:6400
    ds_write_b32 v5, v122 offset:6656
    ds_write_b32 v5, v123 offset:6912
    ds_write_b32 v5, v124 offset:7168
    ds_write_b32 v5, v125 offset:7424
    ds_write_b32 v5, v126 offset:7680
    ds_write_b32 v5, v127 offset:7936
    s_waitcnt lgkmcnt(0)
    s_barrier
    s_lshl_b32 s7, s3, 11
    v_lshl_add_u32 v5, v1, 2, s7
    ds_read_b32 v16, v5 offset:0
    ds_read_b32 v17, v5 offset:8192
    ds_read_b32 v18, v5 offset:16384
    ds_read_b32 v19, v5 offset:24576
    s_waitcnt lgkmcnt(0)
    v_add_f32 v16, v16, v17
    v_add_f32 v18, v18, v19
    v_add_f32 v48, v16, v18
    ds_read_b32 v16, v5 offset:256
    ds_read_b32 v17, v5 offset:8448
    ds_read_b32 v18, v5 offset:16640
    ds_read_b32 v19, v5 offset:24832
    s_waitcnt lgkmcnt(0)
    v_add_f32 v16, v16, v17
    v_add_f32 v18, v18, v19
    v_add_f32 v49, v16, v18
    ds_read_b32 v16, v5 offset:512
    ds_read_b32 v17, v5 offset:8704
    ds_read_b32 v18, v5 offset:16896
    ds_read_b32 v19, v5 offset:25088
    s_waitcnt lgkmcnt(0)
    v_add_f32 v16, v16, v17
    v_add_f32 v18, v18, v19
    v_add_f32 v50, v16, v18
    ds_read_b32 v16, v5 offset:768
    ds_read_b32 v17, v5 offset:8960
    ds_read_b32 v18, v5 offset:17152
    ds_read_b32 v19, v5 offset:25344
    s_waitcnt lgkmcnt(0)
    v_add_f32 v16, v16, v17
    v_add_f32 v18, v18, v19
    v_add_f32 v51, v16, v18
    ds_read_b32 v16, v5 offset:1024
    ds_read_b32 v17, v5 offset:9216
    ds_read_b32 v18, v5 offset:17408
    ds_read_b32 v19, v5 offset:25600
    s_waitcnt lgkmcnt(0)
    v_add_f32 v16, v16, v17
    v_add_f32 v18, v18, v19
    v_add_f32 v52, v16, v18
    ds_read_b32 v16, v5 offset:1280
    ds_read_b32 v17, v5 offset:9472
    ds_read_b32 v18, v5 offset:17664
    ds_read_b32 v19, v5 offset:25856
    s_waitcnt lgkmcnt(0)
    v_add_f32 v16, v16, v17
    v_add_f32 v18, v18, v19
    v_add_f32 v53, v16, v18
    ds_read_b32 v16, v5 offset:1536
    ds_read_b32 v17, v5 offset:9728
    ds_read_b32 v18, v5 offset:17920
    ds_read_b32 v19, v5 offset:26112
    s_waitcnt lgkmcnt(0)
    v_add_f32 v16, v16, v17
    v_add_f32 v18, v18, v19
    v_add_f32 v54, v16, v18
    ds_read_b32 v16, v5 offset:1792
    ds_read_b32 v17, v5 offset:9984
    ds_read_b32 v18, v5 offset:18176
    ds_read_b32 v19, v5 offset:26368
    s_waitcnt lgkmcnt(0)
    v_add_f32 v16, v16, v17
    v_add_f32 v18, v18, v19
    v_add_f32 v55, v16, v18
    s_lshl_b32 s8, s4, 4
    s_add_u32 s8, s8, s5
    s_lshl_b32 s8, s8, 13
    s_add_u32 s8, s8, 4194304
    buffer_store_dword v48, v5, s[44:47], s8 offen offset:0 sc0 sc1
    buffer_store_dword v49, v5, s[44:47], s8 offen offset:256 sc0 sc1
    buffer_store_dword v50, v5, s[44:47], s8 offen offset:512 sc0 sc1
    buffer_store_dword v51, v5, s[44:47], s8 offen offset:768 sc0 sc1
    buffer_store_dword v52, v5, s[44:47], s8 offen offset:1024 sc0 sc1
    buffer_store_dword v53, v5, s[44:47], s8 offen offset:1280 sc0 sc1
    buffer_store_dword v54, v5, s[44:47], s8 offen offset:1536 sc0 sc1
    buffer_store_dword v55, v5, s[44:47], s8 offen offset:1792 sc0 sc1
    s_waitcnt vmcnt(0)
    s_barrier
    s_mov_b32 s48, s40
    s_mov_b32 s49, s41
    s_mov_b32 s50, 256
    s_mov_b32 s51, 0x20000
    v_mov_b32 v6, 1
    s_lshl_b32 s9, s4, 2
    v_mov_b32 v7, s9
    v_cmp_eq_u32 vcc, 0, v0
    s_and_saveexec_b64 s[60:61], vcc
    s_cbranch_execz L_noat
    buffer_atomic_add v6, v7, s[48:51], 0 offen sc0 sc1
    s_waitcnt vmcnt(0)
    ds_write_b32 v0, v6 offset:57344
    s_waitcnt lgkmcnt(0)
L_noat:
    s_or_b64 exec, exec, s[60:61]
    s_barrier
    v_mov_b32 v6, 0
    ds_read_b32 v6, v6 offset:57344
    s_waitcnt lgkmcnt(0)
    s_nop 0
    v_readfirstlane_b32 s9, v6
    s_cmp_eq_u32 s9, 15
    s_cbranch_scc0 L_end1
    s_lshl_b32 s8, s4, 17
    s_add_u32 s8, s8, 4194304
    v_mov_b32 v48, 0
    v_mov_b32 v49, 0
    v_mov_b32 v50, 0
    v_mov_b32 v51, 0
    v_mov_b32 v52, 0
    v_mov_b32 v53, 0
    v_mov_b32 v54, 0
    v_mov_b32 v55, 0
    buffer_load_dword v16, v5, s[44:47], s8 offen offset:0 sc0 sc1
    buffer_load_dword v17, v5, s[44:47], s8 offen offset:256 sc0 sc1
    buffer_load_dword v18, v5, s[44:47], s8 offen offset:512 sc0 sc1
    buffer_load_dword v19, v5, s[44:47], s8 offen offset:768 sc0 sc1
    buffer_load_dword v20, v5, s[44:47], s8 offen offset:1024 sc0 sc1
    buffer_load_dword v21, v5, s[44:47], s8 offen offset:1280 sc0 sc1
    buffer_load_dword v22, v5, s[44:47], s8 offen offset:1536 sc0 sc1
    buffer_load_dword v23, v5, s[44:47], s8 offen offset:1792 sc0 sc1
    s_waitcnt vmcnt(0)
    v_add_f32 v48, v48, v16
    v_add_f32 v49, v49, v17
    v_add_f32 v50, v50, v18
    v_add_f32 v51, v51, v19
    v_add_f32 v52, v52, v20
    v_add_f32 v53, v53, v21
    v_add_f32 v54, v54, v22
    v_add_f32 v55, v55, v23
    s_add_u32 s8, s8, 8192
    buffer_load_dword v16, v5, s[44:47], s8 offen offset:0 sc0 sc1
    buffer_load_dword v17, v5, s[44:47], s8 offen offset:256 sc0 sc1
    buffer_load_dword v18, v5, s[44:47], s8 offen offset:512 sc0 sc1
    buffer_load_dword v19, v5, s[44:47], s8 offen offset:768 sc0 sc1
    buffer_load_dword v20, v5, s[44:47], s8 offen offset:1024 sc0 sc1
    buffer_load_dword v21, v5, s[44:47], s8 offen offset:1280 sc0 sc1
    buffer_load_dword v22, v5, s[44:47], s8 offen offset:1536 sc0 sc1
    buffer_load_dword v23, v5, s[44:47], s8 offen offset:1792 sc0 sc1
    s_waitcnt vmcnt(0)
    v_add_f32 v48, v48, v16
    v_add_f32 v49, v49, v17
    v_add_f32 v50, v50, v18
    v_add_f32 v51, v51, v19
    v_add_f32 v52, v52, v20
    v_add_f32 v53, v53, v21
    v_add_f32 v54, v54, v22
    v_add_f32 v55, v55, v23
    s_add_u32 s8, s8, 8192
    buffer_load_dword v16, v5, s[44:47], s8 offen offset:0 sc0 sc1
    buffer_load_dword v17, v5, s[44:47], s8 offen offset:256 sc0 sc1
    buffer_load_dword v18, v5, s[44:47], s8 offen offset:512 sc0 sc1
    buffer_load_dword v19, v5, s[44:47], s8 offen offset:768 sc0 sc1
    buffer_load_dword v20, v5, s[44:47], s8 offen offset:1024 sc0 sc1
    buffer_load_dword v21, v5, s[44:47], s8 offen offset:1280 sc0 sc1
    buffer_load_dword v22, v5, s[44:47], s8 offen offset:1536 sc0 sc1
    buffer_load_dword v23, v5, s[44:47], s8 offen offset:1792 sc0 sc1
    s_waitcnt vmcnt(0)
    v_add_f32 v48, v48, v16
    v_add_f32 v49, v49, v17
    v_add_f32 v50, v50, v18
    v_add_f32 v51, v51, v19
    v_add_f32 v52, v52, v20
    v_add_f32 v53, v53, v21
    v_add_f32 v54, v54, v22
    v_add_f32 v55, v55, v23
    s_add_u32 s8, s8, 8192
    buffer_load_dword v16, v5, s[44:47], s8 offen offset:0 sc0 sc1
    buffer_load_dword v17, v5, s[44:47], s8 offen offset:256 sc0 sc1
    buffer_load_dword v18, v5, s[44:47], s8 offen offset:512 sc0 sc1
    buffer_load_dword v19, v5, s[44:47], s8 offen offset:768 sc0 sc1
    buffer_load_dword v20, v5, s[44:47], s8 offen offset:1024 sc0 sc1
    buffer_load_dword v21, v5, s[44:47], s8 offen offset:1280 sc0 sc1
    buffer_load_dword v22, v5, s[44:47], s8 offen offset:1536 sc0 sc1
    buffer_load_dword v23, v5, s[44:47], s8 offen offset:1792 sc0 sc1
    s_waitcnt vmcnt(0)
    v_add_f32 v48, v48, v16
    v_add_f32 v49, v49, v17
    v_add_f32 v50, v50, v18
    v_add_f32 v51, v51, v19
    v_add_f32 v52, v52, v20
    v_add_f32 v53, v53, v21
    v_add_f32 v54, v54, v22
    v_add_f32 v55, v55, v23
    s_add_u32 s8, s8, 8192
    buffer_load_dword v16, v5, s[44:47], s8 offen offset:0 sc0 sc1
    buffer_load_dword v17, v5, s[44:47], s8 offen offset:256 sc0 sc1
    buffer_load_dword v18, v5, s[44:47], s8 offen offset:512 sc0 sc1
    buffer_load_dword v19, v5, s[44:47], s8 offen offset:768 sc0 sc1
    buffer_load_dword v20, v5, s[44:47], s8 offen offset:1024 sc0 sc1
    buffer_load_dword v21, v5, s[44:47], s8 offen offset:1280 sc0 sc1
    buffer_load_dword v22, v5, s[44:47], s8 offen offset:1536 sc0 sc1
    buffer_load_dword v23, v5, s[44:47], s8 offen offset:1792 sc0 sc1
    s_waitcnt vmcnt(0)
    v_add_f32 v48, v48, v16
    v_add_f32 v49, v49, v17
    v_add_f32 v50, v50, v18
    v_add_f32 v51, v51, v19
    v_add_f32 v52, v52, v20
    v_add_f32 v53, v53, v21
    v_add_f32 v54, v54, v22
    v_add_f32 v55, v55, v23
    s_add_u32 s8, s8, 8192
    buffer_load_dword v16, v5, s[44:47], s8 offen offset:0 sc0 sc1
    buffer_load_dword v17, v5, s[44:47], s8 offen offset:256 sc0 sc1
    buffer_load_dword v18, v5, s[44:47], s8 offen offset:512 sc0 sc1
    buffer_load_dword v19, v5, s[44:47], s8 offen offset:768 sc0 sc1
    buffer_load_dword v20, v5, s[44:47], s8 offen offset:1024 sc0 sc1
    buffer_load_dword v21, v5, s[44:47], s8 offen offset:1280 sc0 sc1
    buffer_load_dword v22, v5, s[44:47], s8 offen offset:1536 sc0 sc1
    buffer_load_dword v23, v5, s[44:47], s8 offen offset:1792 sc0 sc1
    s_waitcnt vmcnt(0)
    v_add_f32 v48, v48, v16
    v_add_f32 v49, v49, v17
    v_add_f32 v50, v50, v18
    v_add_f32 v51, v51, v19
    v_add_f32 v52, v52, v20
    v_add_f32 v53, v53, v21
    v_add_f32 v54, v54, v22
    v_add_f32 v55, v55, v23
    s_add_u32 s8, s8, 8192
    buffer_load_dword v16, v5, s[44:47], s8 offen offset:0 sc0 sc1
    buffer_load_dword v17, v5, s[44:47], s8 offen offset:256 sc0 sc1
    buffer_load_dword v18, v5, s[44:47], s8 offen offset:512 sc0 sc1
    buffer_load_dword v19, v5, s[44:47], s8 offen offset:768 sc0 sc1
    buffer_load_dword v20, v5, s[44:47], s8 offen offset:1024 sc0 sc1
    buffer_load_dword v21, v5, s[44:47], s8 offen offset:1280 sc0 sc1
    buffer_load_dword v22, v5, s[44:47], s8 offen offset:1536 sc0 sc1
    buffer_load_dword v23, v5, s[44:47], s8 offen offset:1792 sc0 sc1
    s_waitcnt vmcnt(0)
    v_add_f32 v48, v48, v16
    v_add_f32 v49, v49, v17
    v_add_f32 v50, v50, v18
    v_add_f32 v51, v51, v19
    v_add_f32 v52, v52, v20
    v_add_f32 v53, v53, v21
    v_add_f32 v54, v54, v22
    v_add_f32 v55, v55, v23
    s_add_u32 s8, s8, 8192
    buffer_load_dword v16, v5, s[44:47], s8 offen offset:0 sc0 sc1
    buffer_load_dword v17, v5, s[44:47], s8 offen offset:256 sc0 sc1
    buffer_load_dword v18, v5, s[44:47], s8 offen offset:512 sc0 sc1
    buffer_load_dword v19, v5, s[44:47], s8 offen offset:768 sc0 sc1
    buffer_load_dword v20, v5, s[44:47], s8 offen offset:1024 sc0 sc1
    buffer_load_dword v21, v5, s[44:47], s8 offen offset:1280 sc0 sc1
    buffer_load_dword v22, v5, s[44:47], s8 offen offset:1536 sc0 sc1
    buffer_load_dword v23, v5, s[44:47], s8 offen offset:1792 sc0 sc1
    s_waitcnt vmcnt(0)
    v_add_f32 v48, v48, v16
    v_add_f32 v49, v49, v17
    v_add_f32 v50, v50, v18
    v_add_f32 v51, v51, v19
    v_add_f32 v52, v52, v20
    v_add_f32 v53, v53, v21
    v_add_f32 v54, v54, v22
    v_add_f32 v55, v55, v23
    s_add_u32 s8, s8, 8192
    buffer_load_dword v16, v5, s[44:47], s8 offen offset:0 sc0 sc1
    buffer_load_dword v17, v5, s[44:47], s8 offen offset:256 sc0 sc1
    buffer_load_dword v18, v5, s[44:47], s8 offen offset:512 sc0 sc1
    buffer_load_dword v19, v5, s[44:47], s8 offen offset:768 sc0 sc1
    buffer_load_dword v20, v5, s[44:47], s8 offen offset:1024 sc0 sc1
    buffer_load_dword v21, v5, s[44:47], s8 offen offset:1280 sc0 sc1
    buffer_load_dword v22, v5, s[44:47], s8 offen offset:1536 sc0 sc1
    buffer_load_dword v23, v5, s[44:47], s8 offen offset:1792 sc0 sc1
    s_waitcnt vmcnt(0)
    v_add_f32 v48, v48, v16
    v_add_f32 v49, v49, v17
    v_add_f32 v50, v50, v18
    v_add_f32 v51, v51, v19
    v_add_f32 v52, v52, v20
    v_add_f32 v53, v53, v21
    v_add_f32 v54, v54, v22
    v_add_f32 v55, v55, v23
    s_add_u32 s8, s8, 8192
    buffer_load_dword v16, v5, s[44:47], s8 offen offset:0 sc0 sc1
    buffer_load_dword v17, v5, s[44:47], s8 offen offset:256 sc0 sc1
    buffer_load_dword v18, v5, s[44:47], s8 offen offset:512 sc0 sc1
    buffer_load_dword v19, v5, s[44:47], s8 offen offset:768 sc0 sc1
    buffer_load_dword v20, v5, s[44:47], s8 offen offset:1024 sc0 sc1
    buffer_load_dword v21, v5, s[44:47], s8 offen offset:1280 sc0 sc1
    buffer_load_dword v22, v5, s[44:47], s8 offen offset:1536 sc0 sc1
    buffer_load_dword v23, v5, s[44:47], s8 offen offset:1792 sc0 sc1
    s_waitcnt vmcnt(0)
    v_add_f32 v48, v48, v16
    v_add_f32 v49, v49, v17
    v_add_f32 v50, v50, v18
    v_add_f32 v51, v51, v19
    v_add_f32 v52, v52, v20
    v_add_f32 v53, v53, v21
    v_add_f32 v54, v54, v22
    v_add_f32 v55, v55, v23
    s_add_u32 s8, s8, 8192
    buffer_load_dword v16, v5, s[44:47], s8 offen offset:0 sc0 sc1
    buffer_load_dword v17, v5, s[44:47], s8 offen offset:256 sc0 sc1
    buffer_load_dword v18, v5, s[44:47], s8 offen offset:512 sc0 sc1
    buffer_load_dword v19, v5, s[44:47], s8 offen offset:768 sc0 sc1
    buffer_load_dword v20, v5, s[44:47], s8 offen offset:1024 sc0 sc1
    buffer_load_dword v21, v5, s[44:47], s8 offen offset:1280 sc0 sc1
    buffer_load_dword v22, v5, s[44:47], s8 offen offset:1536 sc0 sc1
    buffer_load_dword v23, v5, s[44:47], s8 offen offset:1792 sc0 sc1
    s_waitcnt vmcnt(0)
    v_add_f32 v48, v48, v16
    v_add_f32 v49, v49, v17
    v_add_f32 v50, v50, v18
    v_add_f32 v51, v51, v19
    v_add_f32 v52, v52, v20
    v_add_f32 v53, v53, v21
    v_add_f32 v54, v54, v22
    v_add_f32 v55, v55, v23
    s_add_u32 s8, s8, 8192
    buffer_load_dword v16, v5, s[44:47], s8 offen offset:0 sc0 sc1
    buffer_load_dword v17, v5, s[44:47], s8 offen offset:256 sc0 sc1
    buffer_load_dword v18, v5, s[44:47], s8 offen offset:512 sc0 sc1
    buffer_load_dword v19, v5, s[44:47], s8 offen offset:768 sc0 sc1
    buffer_load_dword v20, v5, s[44:47], s8 offen offset:1024 sc0 sc1
    buffer_load_dword v21, v5, s[44:47], s8 offen offset:1280 sc0 sc1
    buffer_load_dword v22, v5, s[44:47], s8 offen offset:1536 sc0 sc1
    buffer_load_dword v23, v5, s[44:47], s8 offen offset:1792 sc0 sc1
    s_waitcnt vmcnt(0)
    v_add_f32 v48, v48, v16
    v_add_f32 v49, v49, v17
    v_add_f32 v50, v50, v18
    v_add_f32 v51, v51, v19
    v_add_f32 v52, v52, v20
    v_add_f32 v53, v53, v21
    v_add_f32 v54, v54, v22
    v_add_f32 v55, v55, v23
    s_add_u32 s8, s8, 8192
    buffer_load_dword v16, v5, s[44:47], s8 offen offset:0 sc0 sc1
    buffer_load_dword v17, v5, s[44:47], s8 offen offset:256 sc0 sc1
    buffer_load_dword v18, v5, s[44:47], s8 offen offset:512 sc0 sc1
    buffer_load_dword v19, v5, s[44:47], s8 offen offset:768 sc0 sc1
    buffer_load_dword v20, v5, s[44:47], s8 offen offset:1024 sc0 sc1
    buffer_load_dword v21, v5, s[44:47], s8 offen offset:1280 sc0 sc1
    buffer_load_dword v22, v5, s[44:47], s8 offen offset:1536 sc0 sc1
    buffer_load_dword v23, v5, s[44:47], s8 offen offset:1792 sc0 sc1
    s_waitcnt vmcnt(0)
    v_add_f32 v48, v48, v16
    v_add_f32 v49, v49, v17
    v_add_f32 v50, v50, v18
    v_add_f32 v51, v51, v19
    v_add_f32 v52, v52, v20
    v_add_f32 v53, v53, v21
    v_add_f32 v54, v54, v22
    v_add_f32 v55, v55, v23
    s_add_u32 s8, s8, 8192
    buffer_load_dword v16, v5, s[44:47], s8 offen offset:0 sc0 sc1
    buffer_load_dword v17, v5, s[44:47], s8 offen offset:256 sc0 sc1
    buffer_load_dword v18, v5, s[44:47], s8 offen offset:512 sc0 sc1
    buffer_load_dword v19, v5, s[44:47], s8 offen offset:768 sc0 sc1
    buffer_load_dword v20, v5, s[44:47], s8 offen offset:1024 sc0 sc1
    buffer_load_dword v21, v5, s[44:47], s8 offen offset:1280 sc0 sc1
    buffer_load_dword v22, v5, s[44:47], s8 offen offset:1536 sc0 sc1
    buffer_load_dword v23, v5, s[44:47], s8 offen offset:1792 sc0 sc1
    s_waitcnt vmcnt(0)
    v_add_f32 v48, v48, v16
    v_add_f32 v49, v49, v17
    v_add_f32 v50, v50, v18
    v_add_f32 v51, v51, v19
    v_add_f32 v52, v52, v20
    v_add_f32 v53, v53, v21
    v_add_f32 v54, v54, v22
    v_add_f32 v55, v55, v23
    s_add_u32 s8, s8, 8192
    buffer_load_dword v16, v5, s[44:47], s8 offen offset:0 sc0 sc1
    buffer_load_dword v17, v5, s[44:47], s8 offen offset:256 sc0 sc1
    buffer_load_dword v18, v5, s[44:47], s8 offen offset:512 sc0 sc1
    buffer_load_dword v19, v5, s[44:47], s8 offen offset:768 sc0 sc1
    buffer_load_dword v20, v5, s[44:47], s8 offen offset:1024 sc0 sc1
    buffer_load_dword v21, v5, s[44:47], s8 offen offset:1280 sc0 sc1
    buffer_load_dword v22, v5, s[44:47], s8 offen offset:1536 sc0 sc1
    buffer_load_dword v23, v5, s[44:47], s8 offen offset:1792 sc0 sc1
    s_waitcnt vmcnt(0)
    v_add_f32 v48, v48, v16
    v_add_f32 v49, v49, v17
    v_add_f32 v50, v50, v18
    v_add_f32 v51, v51, v19
    v_add_f32 v52, v52, v20
    v_add_f32 v53, v53, v21
    v_add_f32 v54, v54, v22
    v_add_f32 v55, v55, v23
    s_add_u32 s8, s8, 8192
    buffer_load_dword v16, v5, s[44:47], s8 offen offset:0 sc0 sc1
    buffer_load_dword v17, v5, s[44:47], s8 offen offset:256 sc0 sc1
    buffer_load_dword v18, v5, s[44:47], s8 offen offset:512 sc0 sc1
    buffer_load_dword v19, v5, s[44:47], s8 offen offset:768 sc0 sc1
    buffer_load_dword v20, v5, s[44:47], s8 offen offset:1024 sc0 sc1
    buffer_load_dword v21, v5, s[44:47], s8 offen offset:1280 sc0 sc1
    buffer_load_dword v22, v5, s[44:47], s8 offen offset:1536 sc0 sc1
    buffer_load_dword v23, v5, s[44:47], s8 offen offset:1792 sc0 sc1
    s_waitcnt vmcnt(0)
    v_add_f32 v48, v48, v16
    v_add_f32 v49, v49, v17
    v_add_f32 v50, v50, v18
    v_add_f32 v51, v51, v19
    v_add_f32 v52, v52, v20
    v_add_f32 v53, v53, v21
    v_add_f32 v54, v54, v22
    v_add_f32 v55, v55, v23
    s_add_u32 s8, s8, 8192
    v_cvt_pk_bf16_f32 v16, v48, v49
    v_cvt_pk_bf16_f32 v17, v50, v51
    v_cvt_pk_bf16_f32 v18, v52, v53
    v_cvt_pk_bf16_f32 v19, v54, v55
    s_lshl_b32 s8, s4, 12
    s_lshl_b32 s9, s3, 10
    s_add_u32 s8, s8, s9
    s_add_u32 s8, s8, 7340032
    buffer_store_dwordx4 v[16:19], v2, s[44:47], s8 offen
L_end1:
    s_endpgm
L_A:
    s_sub_u32 s4, s2, 256
    s_mov_b32 s48, s16
    s_mov_b32 s49, s17
    s_mov_b32 s50, 1835008
    s_mov_b32 s51, 0x20000
    s_mov_b32 s52, s38
    s_mov_b32 s53, s39
    s_mov_b32 s54, 3670016
    s_mov_b32 s55, 0x20000
    s_lshl_b32 s5, s4, 9
    v_lshl_add_u32 v5, v0, 1, s5
    global_load_ushort v10, v5, s[18:19]
    global_load_ushort v11, v5, s[20:21]
    global_load_ushort v12, v5, s[22:23]
    global_load_ushort v13, v5, s[24:25]
    s_lshl_b32 s5, s4, 1
    v_mov_b32 v6, s5
    global_load_ushort v14, v6, s[26:27]
    global_load_ushort v15, v6, s[28:29]
    v_lshlrev_b32 v7, 3, v0
    v_mul_u32_u24 v7, 896, v7
    v_add_u32 v7, s5, v7
    buffer_load_ushort v40, v7, s[48:51], 0 offen offset:0
    buffer_load_ushort v41, v7, s[48:51], 0 offen offset:896
    buffer_load_ushort v42, v7, s[48:51], 0 offen offset:1792
    buffer_load_ushort v43, v7, s[48:51], 0 offen offset:2688
    v_add_u32 v7, 3584, v7
    buffer_load_ushort v44, v7, s[48:51], 0 offen offset:0
    buffer_load_ushort v45, v7, s[48:51], 0 offen offset:896
    buffer_load_ushort v46, v7, s[48:51], 0 offen offset:1792
    buffer_load_ushort v47, v7, s[48:51], 0 offen offset:2688
    s_waitcnt vmcnt(0)
    v_lshlrev_b32 v10, 16, v10
    v_lshlrev_b32 v11, 16, v11
    v_lshlrev_b32 v12, 16, v12
    v_lshlrev_b32 v13, 16, v13
    v_lshlrev_b32 v14, 16, v14
    v_lshlrev_b32 v15, 16, v15
    v_lshl_or_b32 v48, v41, 16, v40
    v_lshl_or_b32 v49, v43, 16, v42
    v_lshl_or_b32 v50, v45, 16, v44
    v_lshl_or_b32 v51, v47, 16, v46
    v_lshlrev_b32 v6, 4, v0
    ds_write_b128 v6, v[48:51] offset:45824
    v_mov_b32 v48, 0
    v_mov_b32 v49, 0
    v_mov_b32 v50, 0
    v_mov_b32 v51, 0
    v_cmp_gt_u32 vcc, 32, v0
    s_and_saveexec_b64 s[60:61], vcc
    ds_write_b128 v6, v[48:51] offset:45312
    ds_write_b128 v6, v[48:51] offset:45056
    s_or_b64 exec, exec, s[60:61]
    v_mul_f32 v10, 0x3fb8aa3b, v10
    v_exp_f32 v10, v10
    s_nop 0
    v_cvt_pk_bf16_f32 v10, v10, v10
    v_lshlrev_b32 v10, 16, v10
    v_mul_f32 v14, 0x3fb8aa3b, v14
    v_exp_f32 v14, v14
    s_nop 0
    v_cvt_pk_bf16_f32 v14, v14, v14
    v_lshlrev_b32 v14, 16, v14
    v_mul_f32 v10, v10, v14
    v_mul_f32 v10, 0xbfb8aa3b, v10
    v_mul_f32 v11, v11, v14
    v_mul_f32 v11, 0.15915494, v11
    v_mul_f32 v12, v12, v14
    v_mul_f32 v13, v13, v14
    v_add_f32 v12, v12, v12
    v_add_f32 v13, v13, v13
    v_lshrrev_b32 v8, 4, v0
    v_lshlrev_b32 v8, 10, v8
    v_bfe_u32 v9, v0, 2, 2
    v_lshl_add_u32 v8, v9, 8, v8
    v_and_b32 v9, 3, v0
    v_lshl_add_u32 v8, v9, 2, v8
    v_mul_f32 v20, 0.0, v10
    v_exp_f32 v20, v20
    v_mul_f32 v21, 0.0, v11
    v_fract_f32 v21, v21
    v_cos_f32 v22, v21
    v_sin_f32 v21, v21
    s_nop 0
    v_mul_f32 v24, v20, v22
    v_mul_f32 v25, v20, v21
    v_mul_f32 v20, v24, v12
    v_mul_f32 v21, v24, v13
    v_fma_f32 v22, -v25, v13, v20
    v_fma_f32 v25, v25, v12, v21
    v_mov_b32 v24, v22
    v_mul_f32 v20, 16.0, v10
    v_exp_f32 v20, v20
    v_mul_f32 v21, 16.0, v11
    v_fract_f32 v21, v21
    v_cos_f32 v22, v21
    v_sin_f32 v21, v21
    s_nop 0
    v_mul_f32 v26, v20, v22
    v_mul_f32 v27, v20, v21
    v_mul_f32 v20, 1.0, v10
    v_exp_f32 v20, v20
    v_mul_f32 v21, 1.0, v11
    v_fract_f32 v21, v21
    v_cos_f32 v22, v21
    v_sin_f32 v21, v21
    s_nop 0
    v_mul_f32 v30, v20, v22
    v_mul_f32 v31, v20, v21
    v_mov_b32 v28, 1.0
    v_mov_b32 v29, 0
    v_sub_f32 v23, 0, v25
    v_cvt_pk_bf16_f32 v23, v24, v23
    ds_write_b32 v8, v23 offset:0
    v_mul_f32 v20, v24, v26
    v_mul_f32 v21, v24, v27
    v_fma_f32 v22, -v25, v27, v20
    v_fma_f32 v25, v25, v26, v21
    v_mov_b32 v24, v22
    v_sub_f32 v23, 0, v25
    v_cvt_pk_bf16_f32 v23, v24, v23
    ds_write_b32 v8, v23 offset:16
    v_mul_f32 v20, v24, v26
    v_mul_f32 v21, v24, v27
    v_fma_f32 v22, -v25, v27, v20
    v_fma_f32 v25, v25, v26, v21
    v_mov_b32 v24, v22
    v_sub_f32 v23, 0, v25
    v_cvt_pk_bf16_f32 v23, v24, v23
    ds_write_b32 v8, v23 offset:32
    v_mul_f32 v20, v24, v26
    v_mul_f32 v21, v24, v27
    v_fma_f32 v22, -v25, v27, v20
    v_fma_f32 v25, v25, v26, v21
    v_mov_b32 v24, v22
    v_sub_f32 v23, 0, v25
    v_cvt_pk_bf16_f32 v23, v24, v23
    ds_write_b32 v8, v23 offset:48
    v_mul_f32 v20, v24, v26
    v_mul_f32 v21, v24, v27
    v_fma_f32 v22, -v25, v27, v20
    v_fma_f32 v25, v25, v26, v21
    v_mov_b32 v24, v22
    v_sub_f32 v23, 0, v25
    v_cvt_pk_bf16_f32 v23, v24, v23
    ds_write_b32 v8, v23 offset:64
    v_mul_f32 v20, v24, v26
    v_mul_f32 v21, v24, v27
    v_fma_f32 v22, -v25, v27, v20
    v_fma_f32 v25, v25, v26, v21
    v_mov_b32 v24, v22
    v_sub_f32 v23, 0, v25
    v_cvt_pk_bf16_f32 v23, v24, v23
    ds_write_b32 v8, v23 offset:80
    v_mul_f32 v20, v24, v26
    v_mul_f32 v21, v24, v27
    v_fma_f32 v22, -v25, v27, v20
    v_fma_f32 v25, v25, v26, v21
    v_mov_b32 v24, v22
    v_sub_f32 v23, 0, v25
    v_cvt_pk_bf16_f32 v23, v24, v23
    ds_write_b32 v8, v23 offset:96
    v_mul_f32 v20, v24, v26
    v_mul_f32 v21, v24, v27
    v_fma_f32 v22, -v25, v27, v20
    v_fma_f32 v25, v25, v26, v21
    v_mov_b32 v24, v22
    v_sub_f32 v23, 0, v25
    v_cvt_pk_bf16_f32 v23, v24, v23
    ds_write_b32 v8, v23 offset:112
    v_mul_f32 v20, v24, v26
    v_mul_f32 v21, v24, v27
    v_fma_f32 v22, -v25, v27, v20
    v_fma_f32 v25, v25, v26, v21
    v_mov_b32 v24, v22
    v_sub_f32 v23, 0, v25
    v_cvt_pk_bf16_f32 v23, v24, v23
    ds_write_b32 v8, v23 offset:128
    v_mul_f32 v20, v24, v26
    v_mul_f32 v21, v24, v27
    v_fma_f32 v22, -v25, v27, v20
    v_fma_f32 v25, v25, v26, v21
    v_mov_b32 v24, v22
    v_sub_f32 v23, 0, v25
    v_cvt_pk_bf16_f32 v23, v24, v23
    ds_write_b32 v8, v23 offset:144
    v_mul_f32 v20, v24, v26
    v_mul_f32 v21, v24, v27
    v_fma_f32 v22, -v25, v27, v20
    v_fma_f32 v25, v25, v26, v21
    v_mov_b32 v24, v22
    v_sub_f32 v23, 0, v25
    v_cvt_pk_bf16_f32 v23, v24, v23
    ds_write_b32 v8, v23 offset:160
    v_mul_f32 v20, v24, v26
    v_mul_f32 v21, v24, v27
    v_fma_f32 v22, -v25, v27, v20
    v_fma_f32 v25, v25, v26, v21
    v_mov_b32 v24, v22
    v_sub_f32 v23, 0, v25
    v_cvt_pk_bf16_f32 v23, v24, v23
    ds_write_b32 v8, v23 offset:176
    v_mul_f32 v20, v24, v26
    v_mul_f32 v21, v24, v27
    v_fma_f32 v22, -v25, v27, v20
    v_fma_f32 v25, v25, v26, v21
    v_mov_b32 v24, v22
    v_sub_f32 v23, 0, v25
    v_cvt_pk_bf16_f32 v23, v24, v23
    ds_write_b32 v8, v23 offset:192
    v_mul_f32 v20, v24, v26
    v_mul_f32 v21, v24, v27
    v_fma_f32 v22, -v25, v27, v20
    v_fma_f32 v25, v25, v26, v21
    v_mov_b32 v24, v22
    v_sub_f32 v23, 0, v25
    v_cvt_pk_bf16_f32 v23, v24, v23
    ds_write_b32 v8, v23 offset:208
    v_mul_f32 v20, v24, v26
    v_mul_f32 v21, v24, v27
    v_fma_f32 v22, -v25, v27, v20
    v_fma_f32 v25, v25, v26, v21
    v_mov_b32 v24, v22
    v_sub_f32 v23, 0, v25
    v_cvt_pk_bf16_f32 v23, v24, v23
    ds_write_b32 v8, v23 offset:224
    v_mul_f32 v20, v24, v26
    v_mul_f32 v21, v24, v27
    v_fma_f32 v22, -v25, v27, v20
    v_fma_f32 v25, v25, v26, v21
    v_mov_b32 v24, v22
    v_sub_f32 v23, 0, v25
    v_cvt_pk_bf16_f32 v23, v24, v23
    ds_write_b32 v8, v23 offset:240
    v_cvt_pk_bf16_f32 v23, v28, v29
    ds_write_b32 v8, v23 offset:16384
    v_mul_f32 v20, v28, v30
    v_mul_f32 v21, v28, v31
    v_fma_f32 v22, -v29, v31, v20
    v_fma_f32 v29, v29, v30, v21
    v_mov_b32 v28, v22
    v_cvt_pk_bf16_f32 v23, v28, v29
    ds_write_b32 v8, v23 offset:16400
    v_mul_f32 v20, v28, v30
    v_mul_f32 v21, v28, v31
    v_fma_f32 v22, -v29, v31, v20
    v_fma_f32 v29, v29, v30, v21
    v_mov_b32 v28, v22
    v_cvt_pk_bf16_f32 v23, v28, v29
    ds_write_b32 v8, v23 offset:16416
    v_mul_f32 v20, v28, v30
    v_mul_f32 v21, v28, v31
    v_fma_f32 v22, -v29, v31, v20
    v_fma_f32 v29, v29, v30, v21
    v_mov_b32 v28, v22
    v_cvt_pk_bf16_f32 v23, v28, v29
    ds_write_b32 v8, v23 offset:16432
    v_mul_f32 v20, v28, v30
    v_mul_f32 v21, v28, v31
    v_fma_f32 v22, -v29, v31, v20
    v_fma_f32 v29, v29, v30, v21
    v_mov_b32 v28, v22
    v_cvt_pk_bf16_f32 v23, v28, v29
    ds_write_b32 v8, v23 offset:16448
    v_mul_f32 v20, v28, v30
    v_mul_f32 v21, v28, v31
    v_fma_f32 v22, -v29, v31, v20
    v_fma_f32 v29, v29, v30, v21
    v_mov_b32 v28, v22
    v_cvt_pk_bf16_f32 v23, v28, v29
    ds_write_b32 v8, v23 offset:16464
    v_mul_f32 v20, v28, v30
    v_mul_f32 v21, v28, v31
    v_fma_f32 v22, -v29, v31, v20
    v_fma_f32 v29, v29, v30, v21
    v_mov_b32 v28, v22
    v_cvt_pk_bf16_f32 v23, v28, v29
    ds_write_b32 v8, v23 offset:16480
    v_mul_f32 v20, v28, v30
    v_mul_f32 v21, v28, v31
    v_fma_f32 v22, -v29, v31, v20
    v_fma_f32 v29, v29, v30, v21
    v_mov_b32 v28, v22
    v_cvt_pk_bf16_f32 v23, v28, v29
    ds_write_b32 v8, v23 offset:16496
    v_mul_f32 v20, v28, v30
    v_mul_f32 v21, v28, v31
    v_fma_f32 v22, -v29, v31, v20
    v_fma_f32 v29, v29, v30, v21
    v_mov_b32 v28, v22
    v_cvt_pk_bf16_f32 v23, v28, v29
    ds_write_b32 v8, v23 offset:16512
    v_mul_f32 v20, v28, v30
    v_mul_f32 v21, v28, v31
    v_fma_f32 v22, -v29, v31, v20
    v_fma_f32 v29, v29, v30, v21
    v_mov_b32 v28, v22
    v_cvt_pk_bf16_f32 v23, v28, v29
    ds_write_b32 v8, v23 offset:16528
    v_mul_f32 v20, v28, v30
    v_mul_f32 v21, v28, v31
    v_fma_f32 v22, -v29, v31, v20
    v_fma_f32 v29, v29, v30, v21
    v_mov_b32 v28, v22
    v_cvt_pk_bf16_f32 v23, v28, v29
    ds_write_b32 v8, v23 offset:16544
    v_mul_f32 v20, v28, v30
    v_mul_f32 v21, v28, v31
    v_fma_f32 v22, -v29, v31, v20
    v_fma_f32 v29, v29, v30, v21
    v_mov_b32 v28, v22
    v_cvt_pk_bf16_f32 v23, v28, v29
    ds_write_b32 v8, v23 offset:16560
    v_mul_f32 v20, v28, v30
    v_mul_f32 v21, v28, v31
    v_fma_f32 v22, -v29, v31, v20
    v_fma_f32 v29, v29, v30, v21
    v_mov_b32 v28, v22
    v_cvt_pk_bf16_f32 v23, v28, v29
    ds_write_b32 v8, v23 offset:16576
    v_mul_f32 v20, v28, v30
    v_mul_f32 v21, v28, v31
    v_fma_f32 v22, -v29, v31, v20
    v_fma_f32 v29, v29, v30, v21
    v_mov_b32 v28, v22
    v_cvt_pk_bf16_f32 v23, v28, v29
    ds_write_b32 v8, v23 offset:16592
    v_mul_f32 v20, v28, v30
    v_mul_f32 v21, v28, v31
    v_fma_f32 v22, -v29, v31, v20
    v_fma_f32 v29, v29, v30, v21
    v_mov_b32 v28, v22
    v_cvt_pk_bf16_f32 v23, v28, v29
    ds_write_b32 v8, v23 offset:16608
    v_mul_f32 v20, v28, v30
    v_mul_f32 v21, v28, v31
    v_fma_f32 v22, -v29, v31, v20
    v_fma_f32 v29, v29, v30, v21
    v_mov_b32 v28, v22
    v_cvt_pk_bf16_f32 v23, v28, v29
    ds_write_b32 v8, v23 offset:16624
    s_waitcnt lgkmcnt(0)
    s_barrier
    s_cmp_eq_u32 s3, 0
    s_cbranch_scc0 L_A0
    v_mov_b32 v32, 0
    v_mov_b32 v33, 0
    v_mov_b32 v34, 0
    v_mov_b32 v35, 0
    v_lshlrev_b32 v9, 4, v1
    ds_read_b128 v[40:43], v9 offset:0
    ds_read_b128 v[44:47], v9 offset:16384
    s_waitcnt lgkmcnt(0)
    v_mfma_f32_16x16x32_bf16 v[32:35], v[40:43], v[44:47], v[32:35]
    s_nop 2
    ds_read_b128 v[40:43], v9 offset:1024
    ds_read_b128 v[44:47], v9 offset:17408
    s_waitcnt lgkmcnt(0)
    v_mfma_f32_16x16x32_bf16 v[32:35], v[40:43], v[44:47], v[32:35]
    s_nop 2
    ds_read_b128 v[40:43], v9 offset:2048
    ds_read_b128 v[44:47], v9 offset:18432
    s_waitcnt lgkmcnt(0)
    v_mfma_f32_16x16x32_bf16 v[32:35], v[40:43], v[44:47], v[32:35]
    s_nop 2
    ds_read_b128 v[40:43], v9 offset:3072
    ds_read_b128 v[44:47], v9 offset:19456
    s_waitcnt lgkmcnt(0)
    v_mfma_f32_16x16x32_bf16 v[32:35], v[40:43], v[44:47], v[32:35]
    s_nop 2
    ds_read_b128 v[40:43], v9 offset:4096
    ds_read_b128 v[44:47], v9 offset:20480
    s_waitcnt lgkmcnt(0)
    v_mfma_f32_16x16x32_bf16 v[32:35], v[40:43], v[44:47], v[32:35]
    s_nop 2
    ds_read_b128 v[40:43], v9 offset:5120
    ds_read_b128 v[44:47], v9 offset:21504
    s_waitcnt lgkmcnt(0)
    v_mfma_f32_16x16x32_bf16 v[32:35], v[40:43], v[44:47], v[32:35]
    s_nop 2
    ds_read_b128 v[40:43], v9 offset:6144
    ds_read_b128 v[44:47], v9 offset:22528
    s_waitcnt lgkmcnt(0)
    v_mfma_f32_16x16x32_bf16 v[32:35], v[40:43], v[44:47], v[32:35]
    s_nop 2
    ds_read_b128 v[40:43], v9 offset:7168
    ds_read_b128 v[44:47], v9 offset:23552
    s_waitcnt lgkmcnt(0)
    v_mfma_f32_16x16x32_bf16 v[32:35], v[40:43], v[44:47], v[32:35]
    s_nop 2
    ds_read_b128 v[40:43], v9 offset:8192
    ds_read_b128 v[44:47], v9 offset:24576
    s_waitcnt lgkmcnt(0)
    v_mfma_f32_16x16x32_bf16 v[32:35], v[40:43], v[44:47], v[32:35]
    s_nop 2
    ds_read_b128 v[40:43], v9 offset:9216
    ds_read_b128 v[44:47], v9 offset:25600
    s_waitcnt lgkmcnt(0)
    v_mfma_f32_16x16x32_bf16 v[32:35], v[40:43], v[44:47], v[32:35]
    s_nop 2
    ds_read_b128 v[40:43], v9 offset:10240
    ds_read_b128 v[44:47], v9 offset:26624
    s_waitcnt lgkmcnt(0)
    v_mfma_f32_16x16x32_bf16 v[32:35], v[40:43], v[44:47], v[32:35]
    s_nop 2
    ds_read_b128 v[40:43], v9 offset:11264
    ds_read_b128 v[44:47], v9 offset:27648
    s_waitcnt lgkmcnt(0)
    v_mfma_f32_16x16x32_bf16 v[32:35], v[40:43], v[44:47], v[32:35]
    s_nop 2
    ds_read_b128 v[40:43], v9 offset:12288
    ds_read_b128 v[44:47], v9 offset:28672
    s_waitcnt lgkmcnt(0)
    v_mfma_f32_16x16x32_bf16 v[32:35], v[40:43], v[44:47], v[32:35]
    s_nop 2
    ds_read_b128 v[40:43], v9 offset:13312
    ds_read_b128 v[44:47], v9 offset:29696
    s_waitcnt lgkmcnt(0)
    v_mfma_f32_16x16x32_bf16 v[32:35], v[40:43], v[44:47], v[32:35]
    s_nop 2
    ds_read_b128 v[40:43], v9 offset:14336
    ds_read_b128 v[44:47], v9 offset:30720
    s_waitcnt lgkmcnt(0)
    v_mfma_f32_16x16x32_bf16 v[32:35], v[40:43], v[44:47], v[32:35]
    s_nop 2
    ds_read_b128 v[40:43], v9 offset:15360
    ds_read_b128 v[44:47], v9 offset:31744
    s_waitcnt lgkmcnt(0)
    v_mfma_f32_16x16x32_bf16 v[32:35], v[40:43], v[44:47], v[32:35]
    s_nop 2
    s_nop 9
    v_lshrrev_b32 v9, 4, v1
    v_lshlrev_b32 v9, 8, v9
    v_and_b32 v7, 15, v1
    v_lshl_add_u32 v9, v7, 2, v9
    ds_write_b32 v9, v32 offset:32768
    ds_write_b32 v9, v33 offset:32832
    ds_write_b32 v9, v34 offset:32896
    ds_write_b32 v9, v35 offset:32960
    s_waitcnt lgkmcnt(0)
L_A0:
    s_barrier
    v_mul_f32 v20, 256.0, v10
    v_exp_f32 v20, v20
    v_mul_f32 v21, 256.0, v11
    v_fract_f32 v21, v21
    v_cos_f32 v22, v21
    v_sin_f32 v21, v21
    s_nop 0
    v_mul_f32 v24, v20, v22
    v_mul_f32 v25, v20, v21
    v_mul_f32 v20, v24, v12
    v_mul_f32 v21, v24, v13
    v_fma_f32 v22, -v25, v13, v20
    v_fma_f32 v25, v25, v12, v21
    v_mov_b32 v24, v22
    v_mul_f32 v20, 32.0, v10
    v_exp_f32 v20, v20
    v_mul_f32 v21, 32.0, v11
    v_fract_f32 v21, v21
    v_cos_f32 v22, v21
    v_sin_f32 v21, v21
    s_nop 0
    v_mul_f32 v26, v20, v22
    v_mul_f32 v27, v20, v21
    v_mul_f32 v20, 2.0, v10
    v_exp_f32 v20, v20
    v_mul_f32 v21, 2.0, v11
    v_fract_f32 v21, v21
    v_cos_f32 v22, v21
    v_sin_f32 v21, v21
    s_nop 0
    v_mul_f32 v30, v20, v22
    v_mul_f32 v31, v20, v21
    v_mov_b32 v28, 1.0
    v_mov_b32 v29, 0
    v_sub_f32 v23, 0, v25
    v_cvt_pk_bf16_f32 v23, v24, v23
    ds_write_b32 v8, v23 offset:0
    v_mul_f32 v20, v24, v26
    v_mul_f32 v21, v24, v27
    v_fma_f32 v22, -v25, v27, v20
    v_fma_f32 v25, v25, v26, v21
    v_mov_b32 v24, v22
    v_sub_f32 v23, 0, v25
    v_cvt_pk_bf16_f32 v23, v24, v23
    ds_write_b32 v8, v23 offset:16
    v_mul_f32 v20, v24, v26
    v_mul_f32 v21, v24, v27
    v_fma_f32 v22, -v25, v27, v20
    v_fma_f32 v25, v25, v26, v21
    v_mov_b32 v24, v22
    v_sub_f32 v23, 0, v25
    v_cvt_pk_bf16_f32 v23, v24, v23
    ds_write_b32 v8, v23 offset:32
    v_mul_f32 v20, v24, v26
    v_mul_f32 v21, v24, v27
    v_fma_f32 v22, -v25, v27, v20
    v_fma_f32 v25, v25, v26, v21
    v_mov_b32 v24, v22
    v_sub_f32 v23, 0, v25
    v_cvt_pk_bf16_f32 v23, v24, v23
    ds_write_b32 v8, v23 offset:48
    v_mul_f32 v20, v24, v26
    v_mul_f32 v21, v24, v27
    v_fma_f32 v22, -v25, v27, v20
    v_fma_f32 v25, v25, v26, v21
    v_mov_b32 v24, v22
    v_sub_f32 v23, 0, v25
    v_cvt_pk_bf16_f32 v23, v24, v23
    ds_write_b32 v8, v23 offset:64
    v_mul_f32 v20, v24, v26
    v_mul_f32 v21, v24, v27
    v_fma_f32 v22, -v25, v27, v20
    v_fma_f32 v25, v25, v26, v21
    v_mov_b32 v24, v22
    v_sub_f32 v23, 0, v25
    v_cvt_pk_bf16_f32 v23, v24, v23
    ds_write_b32 v8, v23 offset:80
    v_mul_f32 v20, v24, v26
    v_mul_f32 v21, v24, v27
    v_fma_f32 v22, -v25, v27, v20
    v_fma_f32 v25, v25, v26, v21
    v_mov_b32 v24, v22
    v_sub_f32 v23, 0, v25
    v_cvt_pk_bf16_f32 v23, v24, v23
    ds_write_b32 v8, v23 offset:96
    v_mul_f32 v20, v24, v26
    v_mul_f32 v21, v24, v27
    v_fma_f32 v22, -v25, v27, v20
    v_fma_f32 v25, v25, v26, v21
    v_mov_b32 v24, v22
    v_sub_f32 v23, 0, v25
    v_cvt_pk_bf16_f32 v23, v24, v23
    ds_write_b32 v8, v23 offset:112
    v_cvt_pk_bf16_f32 v23, v28, v29
    ds_write_b32 v8, v23 offset:16384
    v_mul_f32 v20, v28, v30
    v_mul_f32 v21, v28, v31
    v_fma_f32 v22, -v29, v31, v20
    v_fma_f32 v29, v29, v30, v21
    v_mov_b32 v28, v22
    v_cvt_pk_bf16_f32 v23, v28, v29
    ds_write_b32 v8, v23 offset:16400
    v_mul_f32 v20, v28, v30
    v_mul_f32 v21, v28, v31
    v_fma_f32 v22, -v29, v31, v20
    v_fma_f32 v29, v29, v30, v21
    v_mov_b32 v28, v22
    v_cvt_pk_bf16_f32 v23, v28, v29
    ds_write_b32 v8, v23 offset:16416
    v_mul_f32 v20, v28, v30
    v_mul_f32 v21, v28, v31
    v_fma_f32 v22, -v29, v31, v20
    v_fma_f32 v29, v29, v30, v21
    v_mov_b32 v28, v22
    v_cvt_pk_bf16_f32 v23, v28, v29
    ds_write_b32 v8, v23 offset:16432
    v_mul_f32 v20, v28, v30
    v_mul_f32 v21, v28, v31
    v_fma_f32 v22, -v29, v31, v20
    v_fma_f32 v29, v29, v30, v21
    v_mov_b32 v28, v22
    v_cvt_pk_bf16_f32 v23, v28, v29
    ds_write_b32 v8, v23 offset:16448
    v_mul_f32 v20, v28, v30
    v_mul_f32 v21, v28, v31
    v_fma_f32 v22, -v29, v31, v20
    v_fma_f32 v29, v29, v30, v21
    v_mov_b32 v28, v22
    v_cvt_pk_bf16_f32 v23, v28, v29
    ds_write_b32 v8, v23 offset:16464
    v_mul_f32 v20, v28, v30
    v_mul_f32 v21, v28, v31
    v_fma_f32 v22, -v29, v31, v20
    v_fma_f32 v29, v29, v30, v21
    v_mov_b32 v28, v22
    v_cvt_pk_bf16_f32 v23, v28, v29
    ds_write_b32 v8, v23 offset:16480
    v_mul_f32 v20, v28, v30
    v_mul_f32 v21, v28, v31
    v_fma_f32 v22, -v29, v31, v20
    v_fma_f32 v29, v29, v30, v21
    v_mov_b32 v28, v22
    v_cvt_pk_bf16_f32 v23, v28, v29
    ds_write_b32 v8, v23 offset:16496
    v_mul_f32 v20, v28, v30
    v_mul_f32 v21, v28, v31
    v_fma_f32 v22, -v29, v31, v20
    v_fma_f32 v29, v29, v30, v21
    v_mov_b32 v28, v22
    v_cvt_pk_bf16_f32 v23, v28, v29
    ds_write_b32 v8, v23 offset:16512
    v_mul_f32 v20, v28, v30
    v_mul_f32 v21, v28, v31
    v_fma_f32 v22, -v29, v31, v20
    v_fma_f32 v29, v29, v30, v21
    v_mov_b32 v28, v22
    v_cvt_pk_bf16_f32 v23, v28, v29
    ds_write_b32 v8, v23 offset:16528
    v_mul_f32 v20, v28, v30
    v_mul_f32 v21, v28, v31
    v_fma_f32 v22, -v29, v31, v20
    v_fma_f32 v29, v29, v30, v21
    v_mov_b32 v28, v22
    v_cvt_pk_bf16_f32 v23, v28, v29
    ds_write_b32 v8, v23 offset:16544
    v_mul_f32 v20, v28, v30
    v_mul_f32 v21, v28, v31
    v_fma_f32 v22, -v29, v31, v20
    v_fma_f32 v29, v29, v30, v21
    v_mov_b32 v28, v22
    v_cvt_pk_bf16_f32 v23, v28, v29
    ds_write_b32 v8, v23 offset:16560
    v_mul_f32 v20, v28, v30
    v_mul_f32 v21, v28, v31
    v_fma_f32 v22, -v29, v31, v20
    v_fma_f32 v29, v29, v30, v21
    v_mov_b32 v28, v22
    v_cvt_pk_bf16_f32 v23, v28, v29
    ds_write_b32 v8, v23 offset:16576
    v_mul_f32 v20, v28, v30
    v_mul_f32 v21, v28, v31
    v_fma_f32 v22, -v29, v31, v20
    v_fma_f32 v29, v29, v30, v21
    v_mov_b32 v28, v22
    v_cvt_pk_bf16_f32 v23, v28, v29
    ds_write_b32 v8, v23 offset:16592
    v_mul_f32 v20, v28, v30
    v_mul_f32 v21, v28, v31
    v_fma_f32 v22, -v29, v31, v20
    v_fma_f32 v29, v29, v30, v21
    v_mov_b32 v28, v22
    v_cvt_pk_bf16_f32 v23, v28, v29
    ds_write_b32 v8, v23 offset:16608
    v_mul_f32 v20, v28, v30
    v_mul_f32 v21, v28, v31
    v_fma_f32 v22, -v29, v31, v20
    v_fma_f32 v29, v29, v30, v21
    v_mov_b32 v28, v22
    v_cvt_pk_bf16_f32 v23, v28, v29
    ds_write_b32 v8, v23 offset:16624
    s_waitcnt lgkmcnt(0)
    s_barrier
    s_cmp_eq_u32 s3, 0
    s_cbranch_scc0 L_A1
    v_mov_b32 v32, 0
    v_mov_b32 v33, 0
    v_mov_b32 v34, 0
    v_mov_b32 v35, 0
    v_lshlrev_b32 v9, 4, v1
    ds_read_b128 v[40:43], v9 offset:0
    ds_read_b128 v[44:47], v9 offset:16384
    s_waitcnt lgkmcnt(0)
    v_mfma_f32_16x16x32_bf16 v[32:35], v[40:43], v[44:47], v[32:35]
    s_nop 2
    ds_read_b128 v[40:43], v9 offset:1024
    ds_read_b128 v[44:47], v9 offset:17408
    s_waitcnt lgkmcnt(0)
    v_mfma_f32_16x16x32_bf16 v[32:35], v[40:43], v[44:47], v[32:35]
    s_nop 2
    ds_read_b128 v[40:43], v9 offset:2048
    ds_read_b128 v[44:47], v9 offset:18432
    s_waitcnt lgkmcnt(0)
    v_mfma_f32_16x16x32_bf16 v[32:35], v[40:43], v[44:47], v[32:35]
    s_nop 2
    ds_read_b128 v[40:43], v9 offset:3072
    ds_read_b128 v[44:47], v9 offset:19456
    s_waitcnt lgkmcnt(0)
    v_mfma_f32_16x16x32_bf16 v[32:35], v[40:43], v[44:47], v[32:35]
    s_nop 2
    ds_read_b128 v[40:43], v9 offset:4096
    ds_read_b128 v[44:47], v9 offset:20480
    s_waitcnt lgkmcnt(0)
    v_mfma_f32_16x16x32_bf16 v[32:35], v[40:43], v[44:47], v[32:35]
    s_nop 2
    ds_read_b128 v[40:43], v9 offset:5120
    ds_read_b128 v[44:47], v9 offset:21504
    s_waitcnt lgkmcnt(0)
    v_mfma_f32_16x16x32_bf16 v[32:35], v[40:43], v[44:47], v[32:35]
    s_nop 2
    ds_read_b128 v[40:43], v9 offset:6144
    ds_read_b128 v[44:47], v9 offset:22528
    s_waitcnt lgkmcnt(0)
    v_mfma_f32_16x16x32_bf16 v[32:35], v[40:43], v[44:47], v[32:35]
    s_nop 2
    ds_read_b128 v[40:43], v9 offset:7168
    ds_read_b128 v[44:47], v9 offset:23552
    s_waitcnt lgkmcnt(0)
    v_mfma_f32_16x16x32_bf16 v[32:35], v[40:43], v[44:47], v[32:35]
    s_nop 2
    ds_read_b128 v[40:43], v9 offset:8192
    ds_read_b128 v[44:47], v9 offset:24576
    s_waitcnt lgkmcnt(0)
    v_mfma_f32_16x16x32_bf16 v[32:35], v[40:43], v[44:47], v[32:35]
    s_nop 2
    ds_read_b128 v[40:43], v9 offset:9216
    ds_read_b128 v[44:47], v9 offset:25600
    s_waitcnt lgkmcnt(0)
    v_mfma_f32_16x16x32_bf16 v[32:35], v[40:43], v[44:47], v[32:35]
    s_nop 2
    ds_read_b128 v[40:43], v9 offset:10240
    ds_read_b128 v[44:47], v9 offset:26624
    s_waitcnt lgkmcnt(0)
    v_mfma_f32_16x16x32_bf16 v[32:35], v[40:43], v[44:47], v[32:35]
    s_nop 2
    ds_read_b128 v[40:43], v9 offset:11264
    ds_read_b128 v[44:47], v9 offset:27648
    s_waitcnt lgkmcnt(0)
    v_mfma_f32_16x16x32_bf16 v[32:35], v[40:43], v[44:47], v[32:35]
    s_nop 2
    ds_read_b128 v[40:43], v9 offset:12288
    ds_read_b128 v[44:47], v9 offset:28672
    s_waitcnt lgkmcnt(0)
    v_mfma_f32_16x16x32_bf16 v[32:35], v[40:43], v[44:47], v[32:35]
    s_nop 2
    ds_read_b128 v[40:43], v9 offset:13312
    ds_read_b128 v[44:47], v9 offset:29696
    s_waitcnt lgkmcnt(0)
    v_mfma_f32_16x16x32_bf16 v[32:35], v[40:43], v[44:47], v[32:35]
    s_nop 2
    ds_read_b128 v[40:43], v9 offset:14336
    ds_read_b128 v[44:47], v9 offset:30720
    s_waitcnt lgkmcnt(0)
    v_mfma_f32_16x16x32_bf16 v[32:35], v[40:43], v[44:47], v[32:35]
    s_nop 2
    ds_read_b128 v[40:43], v9 offset:15360
    ds_read_b128 v[44:47], v9 offset:31744
    s_waitcnt lgkmcnt(0)
    v_mfma_f32_16x16x32_bf16 v[32:35], v[40:43], v[44:47], v[32:35]
    s_nop 2
    s_nop 9
    v_lshrrev_b32 v9, 4, v1
    v_lshlrev_b32 v9, 8, v9
    v_and_b32 v7, 15, v1
    v_lshl_add_u32 v9, v7, 2, v9
    ds_write_b32 v9, v32 offset:33792
    ds_write_b32 v9, v33 offset:33856
    ds_write_b32 v9, v34 offset:33920
    ds_write_b32 v9, v35 offset:33984
    s_waitcnt lgkmcnt(0)
L_A1:
    s_barrier
    v_mul_f32 v20, 512.0, v10
    v_exp_f32 v20, v20
    v_mul_f32 v21, 512.0, v11
    v_fract_f32 v21, v21
    v_cos_f32 v22, v21
    v_sin_f32 v21, v21
    s_nop 0
    v_mul_f32 v24, v20, v22
    v_mul_f32 v25, v20, v21
    v_mul_f32 v20, v24, v12
    v_mul_f32 v21, v24, v13
    v_fma_f32 v22, -v25, v13, v20
    v_fma_f32 v25, v25, v12, v21
    v_mov_b32 v24, v22
    v_mul_f32 v20, 64.0, v10
    v_exp_f32 v20, v20
    v_mul_f32 v21, 64.0, v11
    v_fract_f32 v21, v21
    v_cos_f32 v22, v21
    v_sin_f32 v21, v21
    s_nop 0
    v_mul_f32 v26, v20, v22
    v_mul_f32 v27, v20, v21
    v_mul_f32 v20, 4.0, v10
    v_exp_f32 v20, v20
    v_mul_f32 v21, 4.0, v11
    v_fract_f32 v21, v21
    v_cos_f32 v22, v21
    v_sin_f32 v21, v21
    s_nop 0
    v_mul_f32 v30, v20, v22
    v_mul_f32 v31, v20, v21
    v_mov_b32 v28, 1.0
    v_mov_b32 v29, 0
    v_sub_f32 v23, 0, v25
    v_cvt_pk_bf16_f32 v23, v24, v23
    ds_write_b32 v8, v23 offset:0
    v_mul_f32 v20, v24, v26
    v_mul_f32 v21, v24, v27
    v_fma_f32 v22, -v25, v27, v20
    v_fma_f32 v25, v25, v26, v21
    v_mov_b32 v24, v22
    v_sub_f32 v23, 0, v25
    v_cvt_pk_bf16_f32 v23, v24, v23
    ds_write_b32 v8, v23 offset:16
    v_mul_f32 v20, v24, v26
    v_mul_f32 v21, v24, v27
    v_fma_f32 v22, -v25, v27, v20
    v_fma_f32 v25, v25, v26, v21
    v_mov_b32 v24, v22
    v_sub_f32 v23, 0, v25
    v_cvt_pk_bf16_f32 v23, v24, v23
    ds_write_b32 v8, v23 offset:32
    v_mul_f32 v20, v24, v26
    v_mul_f32 v21, v24, v27
    v_fma_f32 v22, -v25, v27, v20
    v_fma_f32 v25, v25, v26, v21
    v_mov_b32 v24, v22
    v_sub_f32 v23, 0, v25
    v_cvt_pk_bf16_f32 v23, v24, v23
    ds_write_b32 v8, v23 offset:48
    v_mul_f32 v20, v24, v26
    v_mul_f32 v21, v24, v27
    v_fma_f32 v22, -v25, v27, v20
    v_fma_f32 v25, v25, v26, v21
    v_mov_b32 v24, v22
    v_sub_f32 v23, 0, v25
    v_cvt_pk_bf16_f32 v23, v24, v23
    ds_write_b32 v8, v23 offset:64
    v_mul_f32 v20, v24, v26
    v_mul_f32 v21, v24, v27
    v_fma_f32 v22, -v25, v27, v20
    v_fma_f32 v25, v25, v26, v21
    v_mov_b32 v24, v22
    v_sub_f32 v23, 0, v25
    v_cvt_pk_bf16_f32 v23, v24, v23
    ds_write_b32 v8, v23 offset:80
    v_mul_f32 v20, v24, v26
    v_mul_f32 v21, v24, v27
    v_fma_f32 v22, -v25, v27, v20
    v_fma_f32 v25, v25, v26, v21
    v_mov_b32 v24, v22
    v_sub_f32 v23, 0, v25
    v_cvt_pk_bf16_f32 v23, v24, v23
    ds_write_b32 v8, v23 offset:96
    v_mul_f32 v20, v24, v26
    v_mul_f32 v21, v24, v27
    v_fma_f32 v22, -v25, v27, v20
    v_fma_f32 v25, v25, v26, v21
    v_mov_b32 v24, v22
    v_sub_f32 v23, 0, v25
    v_cvt_pk_bf16_f32 v23, v24, v23
    ds_write_b32 v8, v23 offset:112
    v_cvt_pk_bf16_f32 v23, v28, v29
    ds_write_b32 v8, v23 offset:16384
    v_mul_f32 v20, v28, v30
    v_mul_f32 v21, v28, v31
    v_fma_f32 v22, -v29, v31, v20
    v_fma_f32 v29, v29, v30, v21
    v_mov_b32 v28, v22
    v_cvt_pk_bf16_f32 v23, v28, v29
    ds_write_b32 v8, v23 offset:16400
    v_mul_f32 v20, v28, v30
    v_mul_f32 v21, v28, v31
    v_fma_f32 v22, -v29, v31, v20
    v_fma_f32 v29, v29, v30, v21
    v_mov_b32 v28, v22
    v_cvt_pk_bf16_f32 v23, v28, v29
    ds_write_b32 v8, v23 offset:16416
    v_mul_f32 v20, v28, v30
    v_mul_f32 v21, v28, v31
    v_fma_f32 v22, -v29, v31, v20
    v_fma_f32 v29, v29, v30, v21
    v_mov_b32 v28, v22
    v_cvt_pk_bf16_f32 v23, v28, v29
    ds_write_b32 v8, v23 offset:16432
    v_mul_f32 v20, v28, v30
    v_mul_f32 v21, v28, v31
    v_fma_f32 v22, -v29, v31, v20
    v_fma_f32 v29, v29, v30, v21
    v_mov_b32 v28, v22
    v_cvt_pk_bf16_f32 v23, v28, v29
    ds_write_b32 v8, v23 offset:16448
    v_mul_f32 v20, v28, v30
    v_mul_f32 v21, v28, v31
    v_fma_f32 v22, -v29, v31, v20
    v_fma_f32 v29, v29, v30, v21
    v_mov_b32 v28, v22
    v_cvt_pk_bf16_f32 v23, v28, v29
    ds_write_b32 v8, v23 offset:16464
    v_mul_f32 v20, v28, v30
    v_mul_f32 v21, v28, v31
    v_fma_f32 v22, -v29, v31, v20
    v_fma_f32 v29, v29, v30, v21
    v_mov_b32 v28, v22
    v_cvt_pk_bf16_f32 v23, v28, v29
    ds_write_b32 v8, v23 offset:16480
    v_mul_f32 v20, v28, v30
    v_mul_f32 v21, v28, v31
    v_fma_f32 v22, -v29, v31, v20
    v_fma_f32 v29, v29, v30, v21
    v_mov_b32 v28, v22
    v_cvt_pk_bf16_f32 v23, v28, v29
    ds_write_b32 v8, v23 offset:16496
    v_mul_f32 v20, v28, v30
    v_mul_f32 v21, v28, v31
    v_fma_f32 v22, -v29, v31, v20
    v_fma_f32 v29, v29, v30, v21
    v_mov_b32 v28, v22
    v_cvt_pk_bf16_f32 v23, v28, v29
    ds_write_b32 v8, v23 offset:16512
    v_mul_f32 v20, v28, v30
    v_mul_f32 v21, v28, v31
    v_fma_f32 v22, -v29, v31, v20
    v_fma_f32 v29, v29, v30, v21
    v_mov_b32 v28, v22
    v_cvt_pk_bf16_f32 v23, v28, v29
    ds_write_b32 v8, v23 offset:16528
    v_mul_f32 v20, v28, v30
    v_mul_f32 v21, v28, v31
    v_fma_f32 v22, -v29, v31, v20
    v_fma_f32 v29, v29, v30, v21
    v_mov_b32 v28, v22
    v_cvt_pk_bf16_f32 v23, v28, v29
    ds_write_b32 v8, v23 offset:16544
    v_mul_f32 v20, v28, v30
    v_mul_f32 v21, v28, v31
    v_fma_f32 v22, -v29, v31, v20
    v_fma_f32 v29, v29, v30, v21
    v_mov_b32 v28, v22
    v_cvt_pk_bf16_f32 v23, v28, v29
    ds_write_b32 v8, v23 offset:16560
    v_mul_f32 v20, v28, v30
    v_mul_f32 v21, v28, v31
    v_fma_f32 v22, -v29, v31, v20
    v_fma_f32 v29, v29, v30, v21
    v_mov_b32 v28, v22
    v_cvt_pk_bf16_f32 v23, v28, v29
    ds_write_b32 v8, v23 offset:16576
    v_mul_f32 v20, v28, v30
    v_mul_f32 v21, v28, v31
    v_fma_f32 v22, -v29, v31, v20
    v_fma_f32 v29, v29, v30, v21
    v_mov_b32 v28, v22
    v_cvt_pk_bf16_f32 v23, v28, v29
    ds_write_b32 v8, v23 offset:16592
    v_mul_f32 v20, v28, v30
    v_mul_f32 v21, v28, v31
    v_fma_f32 v22, -v29, v31, v20
    v_fma_f32 v29, v29, v30, v21
    v_mov_b32 v28, v22
    v_cvt_pk_bf16_f32 v23, v28, v29
    ds_write_b32 v8, v23 offset:16608
    v_mul_f32 v20, v28, v30
    v_mul_f32 v21, v28, v31
    v_fma_f32 v22, -v29, v31, v20
    v_fma_f32 v29, v29, v30, v21
    v_mov_b32 v28, v22
    v_cvt_pk_bf16_f32 v23, v28, v29
    ds_write_b32 v8, v23 offset:16624
    s_waitcnt lgkmcnt(0)
    s_barrier
    s_cmp_eq_u32 s3, 0
    s_cbranch_scc0 L_A2
    v_mov_b32 v32, 0
    v_mov_b32 v33, 0
    v_mov_b32 v34, 0
    v_mov_b32 v35, 0
    v_lshlrev_b32 v9, 4, v1
    ds_read_b128 v[40:43], v9 offset:0
    ds_read_b128 v[44:47], v9 offset:16384
    s_waitcnt lgkmcnt(0)
    v_mfma_f32_16x16x32_bf16 v[32:35], v[40:43], v[44:47], v[32:35]
    s_nop 2
    ds_read_b128 v[40:43], v9 offset:1024
    ds_read_b128 v[44:47], v9 offset:17408
    s_waitcnt lgkmcnt(0)
    v_mfma_f32_16x16x32_bf16 v[32:35], v[40:43], v[44:47], v[32:35]
    s_nop 2
    ds_read_b128 v[40:43], v9 offset:2048
    ds_read_b128 v[44:47], v9 offset:18432
    s_waitcnt lgkmcnt(0)
    v_mfma_f32_16x16x32_bf16 v[32:35], v[40:43], v[44:47], v[32:35]
    s_nop 2
    ds_read_b128 v[40:43], v9 offset:3072
    ds_read_b128 v[44:47], v9 offset:19456
    s_waitcnt lgkmcnt(0)
    v_mfma_f32_16x16x32_bf16 v[32:35], v[40:43], v[44:47], v[32:35]
    s_nop 2
    ds_read_b128 v[40:43], v9 offset:4096
    ds_read_b128 v[44:47], v9 offset:20480
    s_waitcnt lgkmcnt(0)
    v_mfma_f32_16x16x32_bf16 v[32:35], v[40:43], v[44:47], v[32:35]
    s_nop 2
    ds_read_b128 v[40:43], v9 offset:5120
    ds_read_b128 v[44:47], v9 offset:21504
    s_waitcnt lgkmcnt(0)
    v_mfma_f32_16x16x32_bf16 v[32:35], v[40:43], v[44:47], v[32:35]
    s_nop 2
    ds_read_b128 v[40:43], v9 offset:6144
    ds_read_b128 v[44:47], v9 offset:22528
    s_waitcnt lgkmcnt(0)
    v_mfma_f32_16x16x32_bf16 v[32:35], v[40:43], v[44:47], v[32:35]
    s_nop 2
    ds_read_b128 v[40:43], v9 offset:7168
    ds_read_b128 v[44:47], v9 offset:23552
    s_waitcnt lgkmcnt(0)
    v_mfma_f32_16x16x32_bf16 v[32:35], v[40:43], v[44:47], v[32:35]
    s_nop 2
    ds_read_b128 v[40:43], v9 offset:8192
    ds_read_b128 v[44:47], v9 offset:24576
    s_waitcnt lgkmcnt(0)
    v_mfma_f32_16x16x32_bf16 v[32:35], v[40:43], v[44:47], v[32:35]
    s_nop 2
    ds_read_b128 v[40:43], v9 offset:9216
    ds_read_b128 v[44:47], v9 offset:25600
    s_waitcnt lgkmcnt(0)
    v_mfma_f32_16x16x32_bf16 v[32:35], v[40:43], v[44:47], v[32:35]
    s_nop 2
    ds_read_b128 v[40:43], v9 offset:10240
    ds_read_b128 v[44:47], v9 offset:26624
    s_waitcnt lgkmcnt(0)
    v_mfma_f32_16x16x32_bf16 v[32:35], v[40:43], v[44:47], v[32:35]
    s_nop 2
    ds_read_b128 v[40:43], v9 offset:11264
    ds_read_b128 v[44:47], v9 offset:27648
    s_waitcnt lgkmcnt(0)
    v_mfma_f32_16x16x32_bf16 v[32:35], v[40:43], v[44:47], v[32:35]
    s_nop 2
    ds_read_b128 v[40:43], v9 offset:12288
    ds_read_b128 v[44:47], v9 offset:28672
    s_waitcnt lgkmcnt(0)
    v_mfma_f32_16x16x32_bf16 v[32:35], v[40:43], v[44:47], v[32:35]
    s_nop 2
    ds_read_b128 v[40:43], v9 offset:13312
    ds_read_b128 v[44:47], v9 offset:29696
    s_waitcnt lgkmcnt(0)
    v_mfma_f32_16x16x32_bf16 v[32:35], v[40:43], v[44:47], v[32:35]
    s_nop 2
    ds_read_b128 v[40:43], v9 offset:14336
    ds_read_b128 v[44:47], v9 offset:30720
    s_waitcnt lgkmcnt(0)
    v_mfma_f32_16x16x32_bf16 v[32:35], v[40:43], v[44:47], v[32:35]
    s_nop 2
    ds_read_b128 v[40:43], v9 offset:15360
    ds_read_b128 v[44:47], v9 offset:31744
    s_waitcnt lgkmcnt(0)
    v_mfma_f32_16x16x32_bf16 v[32:35], v[40:43], v[44:47], v[32:35]
    s_nop 2
    s_nop 9
    v_lshrrev_b32 v9, 4, v1
    v_lshlrev_b32 v9, 8, v9
    v_and_b32 v7, 15, v1
    v_lshl_add_u32 v9, v7, 2, v9
    ds_write_b32 v9, v32 offset:34816
    ds_write_b32 v9, v33 offset:34880
    ds_write_b32 v9, v34 offset:34944
    ds_write_b32 v9, v35 offset:35008
    s_waitcnt lgkmcnt(0)
L_A2:
    s_barrier
    v_mul_f32 v20, 1024.0, v10
    v_exp_f32 v20, v20
    v_mul_f32 v21, 1024.0, v11
    v_fract_f32 v21, v21
    v_cos_f32 v22, v21
    v_sin_f32 v21, v21
    s_nop 0
    v_mul_f32 v24, v20, v22
    v_mul_f32 v25, v20, v21
    v_mul_f32 v20, v24, v12
    v_mul_f32 v21, v24, v13
    v_fma_f32 v22, -v25, v13, v20
    v_fma_f32 v25, v25, v12, v21
    v_mov_b32 v24, v22
    v_mul_f32 v20, 128.0, v10
    v_exp_f32 v20, v20
    v_mul_f32 v21, 128.0, v11
    v_fract_f32 v21, v21
    v_cos_f32 v22, v21
    v_sin_f32 v21, v21
    s_nop 0
    v_mul_f32 v26, v20, v22
    v_mul_f32 v27, v20, v21
    v_mul_f32 v20, 8.0, v10
    v_exp_f32 v20, v20
    v_mul_f32 v21, 8.0, v11
    v_fract_f32 v21, v21
    v_cos_f32 v22, v21
    v_sin_f32 v21, v21
    s_nop 0
    v_mul_f32 v30, v20, v22
    v_mul_f32 v31, v20, v21
    v_mov_b32 v28, 1.0
    v_mov_b32 v29, 0
    v_sub_f32 v23, 0, v25
    v_cvt_pk_bf16_f32 v23, v24, v23
    ds_write_b32 v8, v23 offset:0
    v_mul_f32 v20, v24, v26
    v_mul_f32 v21, v24, v27
    v_fma_f32 v22, -v25, v27, v20
    v_fma_f32 v25, v25, v26, v21
    v_mov_b32 v24, v22
    v_sub_f32 v23, 0, v25
    v_cvt_pk_bf16_f32 v23, v24, v23
    ds_write_b32 v8, v23 offset:16
    v_mul_f32 v20, v24, v26
    v_mul_f32 v21, v24, v27
    v_fma_f32 v22, -v25, v27, v20
    v_fma_f32 v25, v25, v26, v21
    v_mov_b32 v24, v22
    v_sub_f32 v23, 0, v25
    v_cvt_pk_bf16_f32 v23, v24, v23
    ds_write_b32 v8, v23 offset:32
    v_mul_f32 v20, v24, v26
    v_mul_f32 v21, v24, v27
    v_fma_f32 v22, -v25, v27, v20
    v_fma_f32 v25, v25, v26, v21
    v_mov_b32 v24, v22
    v_sub_f32 v23, 0, v25
    v_cvt_pk_bf16_f32 v23, v24, v23
    ds_write_b32 v8, v23 offset:48
    v_mul_f32 v20, v24, v26
    v_mul_f32 v21, v24, v27
    v_fma_f32 v22, -v25, v27, v20
    v_fma_f32 v25, v25, v26, v21
    v_mov_b32 v24, v22
    v_sub_f32 v23, 0, v25
    v_cvt_pk_bf16_f32 v23, v24, v23
    ds_write_b32 v8, v23 offset:64
    v_mul_f32 v20, v24, v26
    v_mul_f32 v21, v24, v27
    v_fma_f32 v22, -v25, v27, v20
    v_fma_f32 v25, v25, v26, v21
    v_mov_b32 v24, v22
    v_sub_f32 v23, 0, v25
    v_cvt_pk_bf16_f32 v23, v24, v23
    ds_write_b32 v8, v23 offset:80
    v_mul_f32 v20, v24, v26
    v_mul_f32 v21, v24, v27
    v_fma_f32 v22, -v25, v27, v20
    v_fma_f32 v25, v25, v26, v21
    v_mov_b32 v24, v22
    v_sub_f32 v23, 0, v25
    v_cvt_pk_bf16_f32 v23, v24, v23
    ds_write_b32 v8, v23 offset:96
    v_mul_f32 v20, v24, v26
    v_mul_f32 v21, v24, v27
    v_fma_f32 v22, -v25, v27, v20
    v_fma_f32 v25, v25, v26, v21
    v_mov_b32 v24, v22
    v_sub_f32 v23, 0, v25
    v_cvt_pk_bf16_f32 v23, v24, v23
    ds_write_b32 v8, v23 offset:112
    v_mul_f32 v20, v24, v26
    v_mul_f32 v21, v24, v27
    v_fma_f32 v22, -v25, v27, v20
    v_fma_f32 v25, v25, v26, v21
    v_mov_b32 v24, v22
    v_sub_f32 v23, 0, v25
    v_cvt_pk_bf16_f32 v23, v24, v23
    ds_write_b32 v8, v23 offset:128
    v_cvt_pk_bf16_f32 v23, v28, v29
    ds_write_b32 v8, v23 offset:16384
    v_mul_f32 v20, v28, v30
    v_mul_f32 v21, v28, v31
    v_fma_f32 v22, -v29, v31, v20
    v_fma_f32 v29, v29, v30, v21
    v_mov_b32 v28, v22
    v_cvt_pk_bf16_f32 v23, v28, v29
    ds_write_b32 v8, v23 offset:16400
    v_mul_f32 v20, v28, v30
    v_mul_f32 v21, v28, v31
    v_fma_f32 v22, -v29, v31, v20
    v_fma_f32 v29, v29, v30, v21
    v_mov_b32 v28, v22
    v_cvt_pk_bf16_f32 v23, v28, v29
    ds_write_b32 v8, v23 offset:16416
    v_mul_f32 v20, v28, v30
    v_mul_f32 v21, v28, v31
    v_fma_f32 v22, -v29, v31, v20
    v_fma_f32 v29, v29, v30, v21
    v_mov_b32 v28, v22
    v_cvt_pk_bf16_f32 v23, v28, v29
    ds_write_b32 v8, v23 offset:16432
    v_mul_f32 v20, v28, v30
    v_mul_f32 v21, v28, v31
    v_fma_f32 v22, -v29, v31, v20
    v_fma_f32 v29, v29, v30, v21
    v_mov_b32 v28, v22
    v_cvt_pk_bf16_f32 v23, v28, v29
    ds_write_b32 v8, v23 offset:16448
    v_mul_f32 v20, v28, v30
    v_mul_f32 v21, v28, v31
    v_fma_f32 v22, -v29, v31, v20
    v_fma_f32 v29, v29, v30, v21
    v_mov_b32 v28, v22
    v_cvt_pk_bf16_f32 v23, v28, v29
    ds_write_b32 v8, v23 offset:16464
    v_mul_f32 v20, v28, v30
    v_mul_f32 v21, v28, v31
    v_fma_f32 v22, -v29, v31, v20
    v_fma_f32 v29, v29, v30, v21
    v_mov_b32 v28, v22
    v_cvt_pk_bf16_f32 v23, v28, v29
    ds_write_b32 v8, v23 offset:16480
    v_mul_f32 v20, v28, v30
    v_mul_f32 v21, v28, v31
    v_fma_f32 v22, -v29, v31, v20
    v_fma_f32 v29, v29, v30, v21
    v_mov_b32 v28, v22
    v_cvt_pk_bf16_f32 v23, v28, v29
    ds_write_b32 v8, v23 offset:16496
    v_mul_f32 v20, v28, v30
    v_mul_f32 v21, v28, v31
    v_fma_f32 v22, -v29, v31, v20
    v_fma_f32 v29, v29, v30, v21
    v_mov_b32 v28, v22
    v_cvt_pk_bf16_f32 v23, v28, v29
    ds_write_b32 v8, v23 offset:16512
    v_mul_f32 v20, v28, v30
    v_mul_f32 v21, v28, v31
    v_fma_f32 v22, -v29, v31, v20
    v_fma_f32 v29, v29, v30, v21
    v_mov_b32 v28, v22
    v_cvt_pk_bf16_f32 v23, v28, v29
    ds_write_b32 v8, v23 offset:16528
    v_mul_f32 v20, v28, v30
    v_mul_f32 v21, v28, v31
    v_fma_f32 v22, -v29, v31, v20
    v_fma_f32 v29, v29, v30, v21
    v_mov_b32 v28, v22
    v_cvt_pk_bf16_f32 v23, v28, v29
    ds_write_b32 v8, v23 offset:16544
    v_mul_f32 v20, v28, v30
    v_mul_f32 v21, v28, v31
    v_fma_f32 v22, -v29, v31, v20
    v_fma_f32 v29, v29, v30, v21
    v_mov_b32 v28, v22
    v_cvt_pk_bf16_f32 v23, v28, v29
    ds_write_b32 v8, v23 offset:16560
    v_mul_f32 v20, v28, v30
    v_mul_f32 v21, v28, v31
    v_fma_f32 v22, -v29, v31, v20
    v_fma_f32 v29, v29, v30, v21
    v_mov_b32 v28, v22
    v_cvt_pk_bf16_f32 v23, v28, v29
    ds_write_b32 v8, v23 offset:16576
    v_mul_f32 v20, v28, v30
    v_mul_f32 v21, v28, v31
    v_fma_f32 v22, -v29, v31, v20
    v_fma_f32 v29, v29, v30, v21
    v_mov_b32 v28, v22
    v_cvt_pk_bf16_f32 v23, v28, v29
    ds_write_b32 v8, v23 offset:16592
    v_mul_f32 v20, v28, v30
    v_mul_f32 v21, v28, v31
    v_fma_f32 v22, -v29, v31, v20
    v_fma_f32 v29, v29, v30, v21
    v_mov_b32 v28, v22
    v_cvt_pk_bf16_f32 v23, v28, v29
    ds_write_b32 v8, v23 offset:16608
    v_mul_f32 v20, v28, v30
    v_mul_f32 v21, v28, v31
    v_fma_f32 v22, -v29, v31, v20
    v_fma_f32 v29, v29, v30, v21
    v_mov_b32 v28, v22
    v_cvt_pk_bf16_f32 v23, v28, v29
    ds_write_b32 v8, v23 offset:16624
    s_waitcnt lgkmcnt(0)
    s_barrier
    s_cmp_eq_u32 s3, 0
    s_cbranch_scc0 L_A3
    v_mov_b32 v32, 0
    v_mov_b32 v33, 0
    v_mov_b32 v34, 0
    v_mov_b32 v35, 0
    v_lshlrev_b32 v9, 4, v1
    ds_read_b128 v[40:43], v9 offset:0
    ds_read_b128 v[44:47], v9 offset:16384
    s_waitcnt lgkmcnt(0)
    v_mfma_f32_16x16x32_bf16 v[32:35], v[40:43], v[44:47], v[32:35]
    s_nop 2
    ds_read_b128 v[40:43], v9 offset:1024
    ds_read_b128 v[44:47], v9 offset:17408
    s_waitcnt lgkmcnt(0)
    v_mfma_f32_16x16x32_bf16 v[32:35], v[40:43], v[44:47], v[32:35]
    s_nop 2
    ds_read_b128 v[40:43], v9 offset:2048
    ds_read_b128 v[44:47], v9 offset:18432
    s_waitcnt lgkmcnt(0)
    v_mfma_f32_16x16x32_bf16 v[32:35], v[40:43], v[44:47], v[32:35]
    s_nop 2
    ds_read_b128 v[40:43], v9 offset:3072
    ds_read_b128 v[44:47], v9 offset:19456
    s_waitcnt lgkmcnt(0)
    v_mfma_f32_16x16x32_bf16 v[32:35], v[40:43], v[44:47], v[32:35]
    s_nop 2
    ds_read_b128 v[40:43], v9 offset:4096
    ds_read_b128 v[44:47], v9 offset:20480
    s_waitcnt lgkmcnt(0)
    v_mfma_f32_16x16x32_bf16 v[32:35], v[40:43], v[44:47], v[32:35]
    s_nop 2
    ds_read_b128 v[40:43], v9 offset:5120
    ds_read_b128 v[44:47], v9 offset:21504
    s_waitcnt lgkmcnt(0)
    v_mfma_f32_16x16x32_bf16 v[32:35], v[40:43], v[44:47], v[32:35]
    s_nop 2
    ds_read_b128 v[40:43], v9 offset:6144
    ds_read_b128 v[44:47], v9 offset:22528
    s_waitcnt lgkmcnt(0)
    v_mfma_f32_16x16x32_bf16 v[32:35], v[40:43], v[44:47], v[32:35]
    s_nop 2
    ds_read_b128 v[40:43], v9 offset:7168
    ds_read_b128 v[44:47], v9 offset:23552
    s_waitcnt lgkmcnt(0)
    v_mfma_f32_16x16x32_bf16 v[32:35], v[40:43], v[44:47], v[32:35]
    s_nop 2
    ds_read_b128 v[40:43], v9 offset:8192
    ds_read_b128 v[44:47], v9 offset:24576
    s_waitcnt lgkmcnt(0)
    v_mfma_f32_16x16x32_bf16 v[32:35], v[40:43], v[44:47], v[32:35]
    s_nop 2
    ds_read_b128 v[40:43], v9 offset:9216
    ds_read_b128 v[44:47], v9 offset:25600
    s_waitcnt lgkmcnt(0)
    v_mfma_f32_16x16x32_bf16 v[32:35], v[40:43], v[44:47], v[32:35]
    s_nop 2
    ds_read_b128 v[40:43], v9 offset:10240
    ds_read_b128 v[44:47], v9 offset:26624
    s_waitcnt lgkmcnt(0)
    v_mfma_f32_16x16x32_bf16 v[32:35], v[40:43], v[44:47], v[32:35]
    s_nop 2
    ds_read_b128 v[40:43], v9 offset:11264
    ds_read_b128 v[44:47], v9 offset:27648
    s_waitcnt lgkmcnt(0)
    v_mfma_f32_16x16x32_bf16 v[32:35], v[40:43], v[44:47], v[32:35]
    s_nop 2
    ds_read_b128 v[40:43], v9 offset:12288
    ds_read_b128 v[44:47], v9 offset:28672
    s_waitcnt lgkmcnt(0)
    v_mfma_f32_16x16x32_bf16 v[32:35], v[40:43], v[44:47], v[32:35]
    s_nop 2
    ds_read_b128 v[40:43], v9 offset:13312
    ds_read_b128 v[44:47], v9 offset:29696
    s_waitcnt lgkmcnt(0)
    v_mfma_f32_16x16x32_bf16 v[32:35], v[40:43], v[44:47], v[32:35]
    s_nop 2
    ds_read_b128 v[40:43], v9 offset:14336
    ds_read_b128 v[44:47], v9 offset:30720
    s_waitcnt lgkmcnt(0)
    v_mfma_f32_16x16x32_bf16 v[32:35], v[40:43], v[44:47], v[32:35]
    s_nop 2
    ds_read_b128 v[40:43], v9 offset:15360
    ds_read_b128 v[44:47], v9 offset:31744
    s_waitcnt lgkmcnt(0)
    v_mfma_f32_16x16x32_bf16 v[32:35], v[40:43], v[44:47], v[32:35]
    s_nop 2
    s_nop 9
    v_lshrrev_b32 v9, 4, v1
    v_lshlrev_b32 v9, 8, v9
    v_and_b32 v7, 15, v1
    v_lshl_add_u32 v9, v7, 2, v9
    ds_write_b32 v9, v32 offset:35840
    ds_write_b32 v9, v33 offset:35904
    ds_write_b32 v9, v34 offset:35968
    ds_write_b32 v9, v35 offset:36032
    s_waitcnt lgkmcnt(0)
L_A3:
    s_barrier
    v_lshl_add_u32 v6, v0, 3, 0
    v_cvt_f32_u32 v6, v6
    v_cvt_pk_bf16_f32 v6, v6, v6
    v_lshlrev_b32 v6, 16, v6
    v_cvt_u32_f32 v6, v6
    v_max_u32 v7, 128, v6
    v_ffbh_u32 v7, v7
    v_sub_u32 v7, 24, v7
    v_min_u32 v7, 3, v7
    v_mov_b32 v9, 128
    v_lshlrev_b32 v9, v7, v9
    v_cmp_eq_u32 vcc, 0, v7
    s_nop 1
    v_cndmask_b32 v9, v9, 0, vcc
    v_sub_u32 v6, v6, v9
    v_lshrrev_b32 v6, v7, v6
    v_lshl_add_u32 v6, v7, 8, v6
    v_lshlrev_b32 v6, 2, v6
    ds_read_b32 v47, v6 offset:32768
    v_lshl_add_u32 v6, v0, 3, 1
    v_cvt_f32_u32 v6, v6
    v_cvt_pk_bf16_f32 v6, v6, v6
    v_lshlrev_b32 v6, 16, v6
    v_cvt_u32_f32 v6, v6
    v_max_u32 v7, 128, v6
    v_ffbh_u32 v7, v7
    v_sub_u32 v7, 24, v7
    v_min_u32 v7, 3, v7
    v_mov_b32 v9, 128
    v_lshlrev_b32 v9, v7, v9
    v_cmp_eq_u32 vcc, 0, v7
    s_nop 1
    v_cndmask_b32 v9, v9, 0, vcc
    v_sub_u32 v6, v6, v9
    v_lshrrev_b32 v6, v7, v6
    v_lshl_add_u32 v6, v7, 8, v6
    v_lshlrev_b32 v6, 2, v6
    ds_read_b32 v46, v6 offset:32768
    v_lshl_add_u32 v6, v0, 3, 2
    v_cvt_f32_u32 v6, v6
    v_cvt_pk_bf16_f32 v6, v6, v6
    v_lshlrev_b32 v6, 16, v6
    v_cvt_u32_f32 v6, v6
    v_max_u32 v7, 128, v6
    v_ffbh_u32 v7, v7
    v_sub_u32 v7, 24, v7
    v_min_u32 v7, 3, v7
    v_mov_b32 v9, 128
    v_lshlrev_b32 v9, v7, v9
    v_cmp_eq_u32 vcc, 0, v7
    s_nop 1
    v_cndmask_b32 v9, v9, 0, vcc
    v_sub_u32 v6, v6, v9
    v_lshrrev_b32 v6, v7, v6
    v_lshl_add_u32 v6, v7, 8, v6
    v_lshlrev_b32 v6, 2, v6
    ds_read_b32 v45, v6 offset:32768
    v_lshl_add_u32 v6, v0, 3, 3
    v_cvt_f32_u32 v6, v6
    v_cvt_pk_bf16_f32 v6, v6, v6
    v_lshlrev_b32 v6, 16, v6
    v_cvt_u32_f32 v6, v6
    v_max_u32 v7, 128, v6
    v_ffbh_u32 v7, v7
    v_sub_u32 v7, 24, v7
    v_min_u32 v7, 3, v7
    v_mov_b32 v9, 128
    v_lshlrev_b32 v9, v7, v9
    v_cmp_eq_u32 vcc, 0, v7
    s_nop 1
    v_cndmask_b32 v9, v9, 0, vcc
    v_sub_u32 v6, v6, v9
    v_lshrrev_b32 v6, v7, v6
    v_lshl_add_u32 v6, v7, 8, v6
    v_lshlrev_b32 v6, 2, v6
    ds_read_b32 v44, v6 offset:32768
    v_lshl_add_u32 v6, v0, 3, 4
    v_cvt_f32_u32 v6, v6
    v_cvt_pk_bf16_f32 v6, v6, v6
    v_lshlrev_b32 v6, 16, v6
    v_cvt_u32_f32 v6, v6
    v_max_u32 v7, 128, v6
    v_ffbh_u32 v7, v7
    v_sub_u32 v7, 24, v7
    v_min_u32 v7, 3, v7
    v_mov_b32 v9, 128
    v_lshlrev_b32 v9, v7, v9
    v_cmp_eq_u32 vcc, 0, v7
    s_nop 1
    v_cndmask_b32 v9, v9, 0, vcc
    v_sub_u32 v6, v6, v9
    v_lshrrev_b32 v6, v7, v6
    v_lshl_add_u32 v6, v7, 8, v6
    v_lshlrev_b32 v6, 2, v6
    ds_read_b32 v43, v6 offset:32768
    v_lshl_add_u32 v6, v0, 3, 5
    v_cvt_f32_u32 v6, v6
    v_cvt_pk_bf16_f32 v6, v6, v6
    v_lshlrev_b32 v6, 16, v6
    v_cvt_u32_f32 v6, v6
    v_max_u32 v7, 128, v6
    v_ffbh_u32 v7, v7
    v_sub_u32 v7, 24, v7
    v_min_u32 v7, 3, v7
    v_mov_b32 v9, 128
    v_lshlrev_b32 v9, v7, v9
    v_cmp_eq_u32 vcc, 0, v7
    s_nop 1
    v_cndmask_b32 v9, v9, 0, vcc
    v_sub_u32 v6, v6, v9
    v_lshrrev_b32 v6, v7, v6
    v_lshl_add_u32 v6, v7, 8, v6
    v_lshlrev_b32 v6, 2, v6
    ds_read_b32 v42, v6 offset:32768
    v_lshl_add_u32 v6, v0, 3, 6
    v_cvt_f32_u32 v6, v6
    v_cvt_pk_bf16_f32 v6, v6, v6
    v_lshlrev_b32 v6, 16, v6
    v_cvt_u32_f32 v6, v6
    v_max_u32 v7, 128, v6
    v_ffbh_u32 v7, v7
    v_sub_u32 v7, 24, v7
    v_min_u32 v7, 3, v7
    v_mov_b32 v9, 128
    v_lshlrev_b32 v9, v7, v9
    v_cmp_eq_u32 vcc, 0, v7
    s_nop 1
    v_cndmask_b32 v9, v9, 0, vcc
    v_sub_u32 v6, v6, v9
    v_lshrrev_b32 v6, v7, v6
    v_lshl_add_u32 v6, v7, 8, v6
    v_lshlrev_b32 v6, 2, v6
    ds_read_b32 v41, v6 offset:32768
    v_lshl_add_u32 v6, v0, 3, 7
    v_cvt_f32_u32 v6, v6
    v_cvt_pk_bf16_f32 v6, v6, v6
    v_lshlrev_b32 v6, 16, v6
    v_cvt_u32_f32 v6, v6
    v_max_u32 v7, 128, v6
    v_ffbh_u32 v7, v7
    v_sub_u32 v7, 24, v7
    v_min_u32 v7, 3, v7
    v_mov_b32 v9, 128
    v_lshlrev_b32 v9, v7, v9
    v_cmp_eq_u32 vcc, 0, v7
    s_nop 1
    v_cndmask_b32 v9, v9, 0, vcc
    v_sub_u32 v6, v6, v9
    v_lshrrev_b32 v6, v7, v6
    v_lshl_add_u32 v6, v7, 8, v6
    v_lshlrev_b32 v6, 2, v6
    ds_read_b32 v40, v6 offset:32768
    s_waitcnt lgkmcnt(0)
    v_cvt_pk_bf16_f32 v48, v40, v41
    v_cvt_pk_bf16_f32 v49, v42, v43
    v_cvt_pk_bf16_f32 v50, v44, v45
    v_cvt_pk_bf16_f32 v51, v46, v47
    v_lshlrev_b32 v6, 4, v0
    v_sub_u32 v6, 4080, v6
    ds_write_b128 v6, v[48:51] offset:40960
    s_waitcnt lgkmcnt(0)
    s_barrier
    v_and_b32 v6, 15, v1
    v_lshrrev_b32 v7, 4, v1
    s_mov_b32 s6, s3
    v_mov_b32 v32, 0
    v_mov_b32 v33, 0
    v_mov_b32 v34, 0
    v_mov_b32 v35, 0
    v_lshlrev_b32 v8, 4, v7
    v_lshlrev_b32 v9, 1, v6
    v_sub_u32 v8, v8, v9
    v_add_u32 v8, 45054, v8
    s_lshl_b32 s7, s6, 9
    v_lshlrev_b32 v9, 5, v6
    v_lshl_add_u32 v9, v7, 4, v9
    v_add_u32 v9, s7, v9
    v_add_u32 v9, 45824, v9
    s_lshl_b32 s7, s6, 3
    s_add_u32 s7, s7, 9
L_C0:
    ds_read_b128 v[40:43], v8
    ds_read_b128 v[44:47], v9
    v_subrev_u32 v8, 64, v8
    v_subrev_u32 v9, 64, v9
    s_waitcnt lgkmcnt(0)
    v_mfma_f32_16x16x32_bf16 v[32:35], v[40:43], v[44:47], v[32:35]
    s_sub_u32 s7, s7, 1
    s_cmp_lg_u32 s7, 0
    s_cbranch_scc1 L_C0
    s_nop 9
    s_lshl_b32 s7, s6, 8
    v_lshlrev_b32 v8, 4, v6
    v_lshl_add_u32 v8, v7, 2, v8
    v_add_u32 v8, s7, v8
    v_lshlrev_b32 v9, 1, v8
    ds_read_u16 v40, v9 offset:45824
    ds_read_u16 v41, v9 offset:45826
    ds_read_u16 v42, v9 offset:45828
    ds_read_u16 v43, v9 offset:45830
    v_mul_u32_u24 v8, 1792, v8
    v_add_u32 v8, s5, v8
    s_waitcnt lgkmcnt(0)
    v_lshlrev_b32 v40, 16, v40
    v_mul_f32 v40, v40, v15
    v_cvt_pk_bf16_f32 v40, v40, v40
    v_lshlrev_b32 v40, 16, v40
    v_cvt_pk_bf16_f32 v32, v32, v32
    v_lshlrev_b32 v32, 16, v32
    v_add_f32 v32, v32, v40
    v_cvt_pk_bf16_f32 v32, v32, v32
    buffer_store_short v32, v8, s[52:55], 0 offen
    v_add_u32 v8, 1792, v8
    v_lshlrev_b32 v41, 16, v41
    v_mul_f32 v41, v41, v15
    v_cvt_pk_bf16_f32 v41, v41, v41
    v_lshlrev_b32 v41, 16, v41
    v_cvt_pk_bf16_f32 v33, v33, v33
    v_lshlrev_b32 v33, 16, v33
    v_add_f32 v33, v33, v41
    v_cvt_pk_bf16_f32 v33, v33, v33
    buffer_store_short v33, v8, s[52:55], 0 offen
    v_add_u32 v8, 1792, v8
    v_lshlrev_b32 v42, 16, v42
    v_mul_f32 v42, v42, v15
    v_cvt_pk_bf16_f32 v42, v42, v42
    v_lshlrev_b32 v42, 16, v42
    v_cvt_pk_bf16_f32 v34, v34, v34
    v_lshlrev_b32 v34, 16, v34
    v_add_f32 v34, v34, v42
    v_cvt_pk_bf16_f32 v34, v34, v34
    buffer_store_short v34, v8, s[52:55], 0 offen
    v_add_u32 v8, 1792, v8
    v_lshlrev_b32 v43, 16, v43
    v_mul_f32 v43, v43, v15
    v_cvt_pk_bf16_f32 v43, v43, v43
    v_lshlrev_b32 v43, 16, v43
    v_cvt_pk_bf16_f32 v35, v35, v35
    v_lshlrev_b32 v35, 16, v35
    v_add_f32 v35, v35, v43
    v_cvt_pk_bf16_f32 v35, v35, v35
    buffer_store_short v35, v8, s[52:55], 0 offen
    v_add_u32 v8, 1792, v8
    s_sub_u32 s6, 7, s3
    v_mov_b32 v32, 0
    v_mov_b32 v33, 0
    v_mov_b32 v34, 0
    v_mov_b32 v35, 0
    v_lshlrev_b32 v8, 4, v7
    v_lshlrev_b32 v9, 1, v6
    v_sub_u32 v8, v8, v9
    v_add_u32 v8, 45054, v8
    s_lshl_b32 s7, s6, 9
    v_lshlrev_b32 v9, 5, v6
    v_lshl_add_u32 v9, v7, 4, v9
    v_add_u32 v9, s7, v9
    v_add_u32 v9, 45824, v9
    s_lshl_b32 s7, s6, 3
    s_add_u32 s7, s7, 9
L_C1:
    ds_read_b128 v[40:43], v8
    ds_read_b128 v[44:47], v9
    v_subrev_u32 v8, 64, v8
    v_subrev_u32 v9, 64, v9
    s_waitcnt lgkmcnt(0)
    v_mfma_f32_16x16x32_bf16 v[32:35], v[40:43], v[44:47], v[32:35]
    s_sub_u32 s7, s7, 1
    s_cmp_lg_u32 s7, 0
    s_cbranch_scc1 L_C1
    s_nop 9
    s_lshl_b32 s7, s6, 8
    v_lshlrev_b32 v8, 4, v6
    v_lshl_add_u32 v8, v7, 2, v8
    v_add_u32 v8, s7, v8
    v_lshlrev_b32 v9, 1, v8
    ds_read_u16 v40, v9 offset:45824
    ds_read_u16 v41, v9 offset:45826
    ds_read_u16 v42, v9 offset:45828
    ds_read_u16 v43, v9 offset:45830
    v_mul_u32_u24 v8, 1792, v8
    v_add_u32 v8, s5, v8
    s_waitcnt lgkmcnt(0)
    v_lshlrev_b32 v40, 16, v40
    v_mul_f32 v40, v40, v15
    v_cvt_pk_bf16_f32 v40, v40, v40
    v_lshlrev_b32 v40, 16, v40
    v_cvt_pk_bf16_f32 v32, v32, v32
    v_lshlrev_b32 v32, 16, v32
    v_add_f32 v32, v32, v40
    v_cvt_pk_bf16_f32 v32, v32, v32
    buffer_store_short v32, v8, s[52:55], 0 offen
    v_add_u32 v8, 1792, v8
    v_lshlrev_b32 v41, 16, v41
    v_mul_f32 v41, v41, v15
    v_cvt_pk_bf16_f32 v41, v41, v41
    v_lshlrev_b32 v41, 16, v41
    v_cvt_pk_bf16_f32 v33, v33, v33
    v_lshlrev_b32 v33, 16, v33
    v_add_f32 v33, v33, v41
    v_cvt_pk_bf16_f32 v33, v33, v33
    buffer_store_short v33, v8, s[52:55], 0 offen
    v_add_u32 v8, 1792, v8
    v_lshlrev_b32 v42, 16, v42
    v_mul_f32 v42, v42, v15
    v_cvt_pk_bf16_f32 v42, v42, v42
    v_lshlrev_b32 v42, 16, v42
    v_cvt_pk_bf16_f32 v34, v34, v34
    v_lshlrev_b32 v34, 16, v34
    v_add_f32 v34, v34, v42
    v_cvt_pk_bf16_f32 v34, v34, v34
    buffer_store_short v34, v8, s[52:55], 0 offen
    v_add_u32 v8, 1792, v8
    v_lshlrev_b32 v43, 16, v43
    v_mul_f32 v43, v43, v15
    v_cvt_pk_bf16_f32 v43, v43, v43
    v_lshlrev_b32 v43, 16, v43
    v_cvt_pk_bf16_f32 v35, v35, v35
    v_lshlrev_b32 v35, 16, v35
    v_add_f32 v35, v35, v43
    v_cvt_pk_bf16_f32 v35, v35, v35
    buffer_store_short v35, v8, s[52:55], 0 offen
    v_add_u32 v8, 1792, v8
    s_endpgm
.globl concat_heads__ssm_conv_s4d__linear_kernel_hedgehog__prompt_s2_kernel
.p2align 8
.type concat_heads__ssm_conv_s4d__linear_kernel_hedgehog__prompt_s2_kernel,@function
concat_heads__ssm_conv_s4d__linear_kernel_hedgehog__prompt_s2_kernel:
    s_load_dwordx2 s[38:39], s[0:1], 88
    s_load_dwordx2 s[42:43], s[0:1], 104
    v_and_b32 v1, 63, v0
    v_lshrrev_b32 v2, 6, v0
    s_nop 0
    v_readfirstlane_b32 s3, v2
    v_and_b32 v3, 31, v1
    v_lshrrev_b32 v4, 5, v1
    v_lshlrev_b32 v15, 4, v1
    s_waitcnt lgkmcnt(0)
    s_cmp_lt_u32 s2, 128
    s_cbranch_scc0 L_end2
    s_mov_b32 s44, s42
    s_mov_b32 s45, s43
    s_mov_b32 s46, 268435456
    s_mov_b32 s47, 0x20000
    s_mov_b32 s48, s38
    s_mov_b32 s49, s39
    s_mov_b32 s50, 3670016
    s_mov_b32 s51, 0x20000
    s_lshr_b32 s4, s2, 1
    s_and_b32 s5, s2, 1
    s_lshl_b32 s6, s3, 2
    s_add_u32 s6, s6, 0
    s_lshl_b32 s7, s4, 4
    s_add_u32 s7, s7, s6
    s_lshl_b32 s7, s7, 12
    s_lshl_b32 s8, s6, 12
    s_add_u32 s8, s8, 7340032
    buffer_load_dwordx4 v[16:19], v15, s[44:47], s7 offen offset:0
    buffer_load_dwordx4 v[32:35], v15, s[44:47], s8 offen offset:0
    buffer_load_dwordx4 v[20:23], v15, s[44:47], s7 offen offset:1024
    buffer_load_dwordx4 v[36:39], v15, s[44:47], s8 offen offset:1024
    buffer_load_dwordx4 v[24:27], v15, s[44:47], s7 offen offset:2048
    buffer_load_dwordx4 v[40:43], v15, s[44:47], s8 offen offset:2048
    buffer_load_dwordx4 v[28:31], v15, s[44:47], s7 offen offset:3072
    buffer_load_dwordx4 v[44:47], v15, s[44:47], s8 offen offset:3072
    v_mov_b32 v48, 0
    v_mov_b32 v49, 0
    v_mov_b32 v50, 0
    v_mov_b32 v51, 0
    v_mov_b32 v52, 0
    v_mov_b32 v53, 0
    v_mov_b32 v54, 0
    v_mov_b32 v55, 0
    v_mov_b32 v56, 0
    v_mov_b32 v57, 0
    v_mov_b32 v58, 0
    v_mov_b32 v59, 0
    v_mov_b32 v60, 0
    v_mov_b32 v61, 0
    v_mov_b32 v62, 0
    v_mov_b32 v63, 0
    s_waitcnt vmcnt(0)
    v_mfma_f32_32x32x16_bf16 v[48:63], v[32:35], v[16:19], v[48:63]
    v_mfma_f32_32x32x16_bf16 v[48:63], v[36:39], v[20:23], v[48:63]
    v_mfma_f32_32x32x16_bf16 v[48:63], v[40:43], v[24:27], v[48:63]
    v_mfma_f32_32x32x16_bf16 v[48:63], v[44:47], v[28:31], v[48:63]
    s_nop 15
    v_cvt_pk_bf16_f32 v5, v60, v60
    v_lshlrev_b32 v5, 16, v5
    v_add_f32 v5, 0x358637bd, v5
    v_cvt_pk_bf16_f32 v5, v5, v5
    v_lshlrev_b32 v5, 16, v5
    v_mov_b32 v6, v5
    s_nop 1
    v_permlane32_swap_b32 v5, v6
    s_nop 1
    v_rcp_f32 v6, v6
    s_nop 0
    v_cvt_pk_bf16_f32 v7, v48, v49
    v_lshlrev_b32 v8, 16, v7
    v_and_b32 v9, 0xffff0000, v7
    v_mul_f32 v8, v8, v6
    v_mul_f32 v9, v9, v6
    v_cvt_pk_bf16_f32 v16, v8, v9
    v_cvt_pk_bf16_f32 v7, v50, v51
    v_lshlrev_b32 v8, 16, v7
    v_and_b32 v9, 0xffff0000, v7
    v_mul_f32 v8, v8, v6
    v_mul_f32 v9, v9, v6
    v_cvt_pk_bf16_f32 v17, v8, v9
    v_cvt_pk_bf16_f32 v7, v52, v53
    v_lshlrev_b32 v8, 16, v7
    v_and_b32 v9, 0xffff0000, v7
    v_mul_f32 v8, v8, v6
    v_mul_f32 v9, v9, v6
    v_cvt_pk_bf16_f32 v18, v8, v9
    v_cvt_pk_bf16_f32 v7, v54, v55
    v_lshlrev_b32 v8, 16, v7
    v_and_b32 v9, 0xffff0000, v7
    v_mul_f32 v8, v8, v6
    v_mul_f32 v9, v9, v6
    v_cvt_pk_bf16_f32 v19, v8, v9
    v_cvt_pk_bf16_f32 v7, v56, v57
    v_lshlrev_b32 v8, 16, v7
    v_and_b32 v9, 0xffff0000, v7
    v_mul_f32 v8, v8, v6
    v_mul_f32 v9, v9, v6
    v_cvt_pk_bf16_f32 v20, v8, v9
    v_cvt_pk_bf16_f32 v7, v58, v59
    v_lshlrev_b32 v8, 16, v7
    v_and_b32 v9, 0xffff0000, v7
    v_mul_f32 v8, v8, v6
    v_mul_f32 v9, v9, v6
    v_cvt_pk_bf16_f32 v21, v8, v9
    v_cvt_pk_bf16_f32 v7, v60, v61
    v_lshlrev_b32 v8, 16, v7
    v_and_b32 v9, 0xffff0000, v7
    v_mul_f32 v8, v8, v6
    v_mul_f32 v9, v9, v6
    v_cvt_pk_bf16_f32 v22, v8, v9
    v_cvt_pk_bf16_f32 v7, v62, v63
    v_lshlrev_b32 v8, 16, v7
    v_and_b32 v9, 0xffff0000, v7
    v_mul_f32 v8, v8, v6
    v_mul_f32 v9, v9, v6
    v_cvt_pk_bf16_f32 v23, v8, v9
    s_lshl_b32 s7, s6, 11
    v_add_u32 v5, s7, v15
    ds_write_b128 v5, v[16:19]
    ds_write_b128 v5, v[20:23] offset:1024
    s_lshl_b32 s6, s3, 2
    s_add_u32 s6, s6, 1
    s_lshl_b32 s7, s4, 4
    s_add_u32 s7, s7, s6
    s_lshl_b32 s7, s7, 12
    s_lshl_b32 s8, s6, 12
    s_add_u32 s8, s8, 7340032
    buffer_load_dwordx4 v[16:19], v15, s[44:47], s7 offen offset:0
    buffer_load_dwordx4 v[32:35], v15, s[44:47], s8 offen offset:0
    buffer_load_dwordx4 v[20:23], v15, s[44:47], s7 offen offset:1024
    buffer_load_dwordx4 v[36:39], v15, s[44:47], s8 offen offset:1024
    buffer_load_dwordx4 v[24:27], v15, s[44:47], s7 offen offset:2048
    buffer_load_dwordx4 v[40:43], v15, s[44:47], s8 offen offset:2048
    buffer_load_dwordx4 v[28:31], v15, s[44:47], s7 offen offset:3072
    buffer_load_dwordx4 v[44:47], v15, s[44:47], s8 offen offset:3072
    v_mov_b32 v48, 0
    v_mov_b32 v49, 0
    v_mov_b32 v50, 0
    v_mov_b32 v51, 0
    v_mov_b32 v52, 0
    v_mov_b32 v53, 0
    v_mov_b32 v54, 0
    v_mov_b32 v55, 0
    v_mov_b32 v56, 0
    v_mov_b32 v57, 0
    v_mov_b32 v58, 0
    v_mov_b32 v59, 0
    v_mov_b32 v60, 0
    v_mov_b32 v61, 0
    v_mov_b32 v62, 0
    v_mov_b32 v63, 0
    s_waitcnt vmcnt(0)
    v_mfma_f32_32x32x16_bf16 v[48:63], v[32:35], v[16:19], v[48:63]
    v_mfma_f32_32x32x16_bf16 v[48:63], v[36:39], v[20:23], v[48:63]
    v_mfma_f32_32x32x16_bf16 v[48:63], v[40:43], v[24:27], v[48:63]
    v_mfma_f32_32x32x16_bf16 v[48:63], v[44:47], v[28:31], v[48:63]
    s_nop 15
    v_cvt_pk_bf16_f32 v5, v60, v60
    v_lshlrev_b32 v5, 16, v5
    v_add_f32 v5, 0x358637bd, v5
    v_cvt_pk_bf16_f32 v5, v5, v5
    v_lshlrev_b32 v5, 16, v5
    v_mov_b32 v6, v5
    s_nop 1
    v_permlane32_swap_b32 v5, v6
    s_nop 1
    v_rcp_f32 v6, v6
    s_nop 0
    v_cvt_pk_bf16_f32 v7, v48, v49
    v_lshlrev_b32 v8, 16, v7
    v_and_b32 v9, 0xffff0000, v7
    v_mul_f32 v8, v8, v6
    v_mul_f32 v9, v9, v6
    v_cvt_pk_bf16_f32 v16, v8, v9
    v_cvt_pk_bf16_f32 v7, v50, v51
    v_lshlrev_b32 v8, 16, v7
    v_and_b32 v9, 0xffff0000, v7
    v_mul_f32 v8, v8, v6
    v_mul_f32 v9, v9, v6
    v_cvt_pk_bf16_f32 v17, v8, v9
    v_cvt_pk_bf16_f32 v7, v52, v53
    v_lshlrev_b32 v8, 16, v7
    v_and_b32 v9, 0xffff0000, v7
    v_mul_f32 v8, v8, v6
    v_mul_f32 v9, v9, v6
    v_cvt_pk_bf16_f32 v18, v8, v9
    v_cvt_pk_bf16_f32 v7, v54, v55
    v_lshlrev_b32 v8, 16, v7
    v_and_b32 v9, 0xffff0000, v7
    v_mul_f32 v8, v8, v6
    v_mul_f32 v9, v9, v6
    v_cvt_pk_bf16_f32 v19, v8, v9
    v_cvt_pk_bf16_f32 v7, v56, v57
    v_lshlrev_b32 v8, 16, v7
    v_and_b32 v9, 0xffff0000, v7
    v_mul_f32 v8, v8, v6
    v_mul_f32 v9, v9, v6
    v_cvt_pk_bf16_f32 v20, v8, v9
    v_cvt_pk_bf16_f32 v7, v58, v59
    v_lshlrev_b32 v8, 16, v7
    v_and_b32 v9, 0xffff0000, v7
    v_mul_f32 v8, v8, v6
    v_mul_f32 v9, v9, v6
    v_cvt_pk_bf16_f32 v21, v8, v9
    v_cvt_pk_bf16_f32 v7, v60, v61
    v_lshlrev_b32 v8, 16, v7
    v_and_b32 v9, 0xffff0000, v7
    v_mul_f32 v8, v8, v6
    v_mul_f32 v9, v9, v6
    v_cvt_pk_bf16_f32 v22, v8, v9
    v_cvt_pk_bf16_f32 v7, v62, v63
    v_lshlrev_b32 v8, 16, v7
    v_and_b32 v9, 0xffff0000, v7
    v_mul_f32 v8, v8, v6
    v_mul_f32 v9, v9, v6
    v_cvt_pk_bf16_f32 v23, v8, v9
    s_lshl_b32 s7, s6, 11
    v_add_u32 v5, s7, v15
    ds_write_b128 v5, v[16:19]
    ds_write_b128 v5, v[20:23] offset:1024
    s_lshl_b32 s6, s3, 2
    s_add_u32 s6, s6, 2
    s_lshl_b32 s7, s4, 4
    s_add_u32 s7, s7, s6
    s_lshl_b32 s7, s7, 12
    s_lshl_b32 s8, s6, 12
    s_add_u32 s8, s8, 7340032
    buffer_load_dwordx4 v[16:19], v15, s[44:47], s7 offen offset:0
    buffer_load_dwordx4 v[32:35], v15, s[44:47], s8 offen offset:0
    buffer_load_dwordx4 v[20:23], v15, s[44:47], s7 offen offset:1024
    buffer_load_dwordx4 v[36:39], v15, s[44:47], s8 offen offset:1024
    buffer_load_dwordx4 v[24:27], v15, s[44:47], s7 offen offset:2048
    buffer_load_dwordx4 v[40:43], v15, s[44:47], s8 offen offset:2048
    buffer_load_dwordx4 v[28:31], v15, s[44:47], s7 offen offset:3072
    buffer_load_dwordx4 v[44:47], v15, s[44:47], s8 offen offset:3072
    v_mov_b32 v48, 0
    v_mov_b32 v49, 0
    v_mov_b32 v50, 0
    v_mov_b32 v51, 0
    v_mov_b32 v52, 0
    v_mov_b32 v53, 0
    v_mov_b32 v54, 0
    v_mov_b32 v55, 0
    v_mov_b32 v56, 0
    v_mov_b32 v57, 0
    v_mov_b32 v58, 0
    v_mov_b32 v59, 0
    v_mov_b32 v60, 0
    v_mov_b32 v61, 0
    v_mov_b32 v62, 0
    v_mov_b32 v63, 0
    s_waitcnt vmcnt(0)
    v_mfma_f32_32x32x16_bf16 v[48:63], v[32:35], v[16:19], v[48:63]
    v_mfma_f32_32x32x16_bf16 v[48:63], v[36:39], v[20:23], v[48:63]
    v_mfma_f32_32x32x16_bf16 v[48:63], v[40:43], v[24:27], v[48:63]
    v_mfma_f32_32x32x16_bf16 v[48:63], v[44:47], v[28:31], v[48:63]
    s_nop 15
    v_cvt_pk_bf16_f32 v5, v60, v60
    v_lshlrev_b32 v5, 16, v5
    v_add_f32 v5, 0x358637bd, v5
    v_cvt_pk_bf16_f32 v5, v5, v5
    v_lshlrev_b32 v5, 16, v5
    v_mov_b32 v6, v5
    s_nop 1
    v_permlane32_swap_b32 v5, v6
    s_nop 1
    v_rcp_f32 v6, v6
    s_nop 0
    v_cvt_pk_bf16_f32 v7, v48, v49
    v_lshlrev_b32 v8, 16, v7
    v_and_b32 v9, 0xffff0000, v7
    v_mul_f32 v8, v8, v6
    v_mul_f32 v9, v9, v6
    v_cvt_pk_bf16_f32 v16, v8, v9
    v_cvt_pk_bf16_f32 v7, v50, v51
    v_lshlrev_b32 v8, 16, v7
    v_and_b32 v9, 0xffff0000, v7
    v_mul_f32 v8, v8, v6
    v_mul_f32 v9, v9, v6
    v_cvt_pk_bf16_f32 v17, v8, v9
    v_cvt_pk_bf16_f32 v7, v52, v53
    v_lshlrev_b32 v8, 16, v7
    v_and_b32 v9, 0xffff0000, v7
    v_mul_f32 v8, v8, v6
    v_mul_f32 v9, v9, v6
    v_cvt_pk_bf16_f32 v18, v8, v9
    v_cvt_pk_bf16_f32 v7, v54, v55
    v_lshlrev_b32 v8, 16, v7
    v_and_b32 v9, 0xffff0000, v7
    v_mul_f32 v8, v8, v6
    v_mul_f32 v9, v9, v6
    v_cvt_pk_bf16_f32 v19, v8, v9
    v_cvt_pk_bf16_f32 v7, v56, v57
    v_lshlrev_b32 v8, 16, v7
    v_and_b32 v9, 0xffff0000, v7
    v_mul_f32 v8, v8, v6
    v_mul_f32 v9, v9, v6
    v_cvt_pk_bf16_f32 v20, v8, v9
    v_cvt_pk_bf16_f32 v7, v58, v59
    v_lshlrev_b32 v8, 16, v7
    v_and_b32 v9, 0xffff0000, v7
    v_mul_f32 v8, v8, v6
    v_mul_f32 v9, v9, v6
    v_cvt_pk_bf16_f32 v21, v8, v9
    v_cvt_pk_bf16_f32 v7, v60, v61
    v_lshlrev_b32 v8, 16, v7
    v_and_b32 v9, 0xffff0000, v7
    v_mul_f32 v8, v8, v6
    v_mul_f32 v9, v9, v6
    v_cvt_pk_bf16_f32 v22, v8, v9
    v_cvt_pk_bf16_f32 v7, v62, v63
    v_lshlrev_b32 v8, 16, v7
    v_and_b32 v9, 0xffff0000, v7
    v_mul_f32 v8, v8, v6
    v_mul_f32 v9, v9, v6
    v_cvt_pk_bf16_f32 v23, v8, v9
    s_lshl_b32 s7, s6, 11
    v_add_u32 v5, s7, v15
    ds_write_b128 v5, v[16:19]
    ds_write_b128 v5, v[20:23] offset:1024
    s_lshl_b32 s6, s3, 2
    s_add_u32 s6, s6, 3
    s_lshl_b32 s7, s4, 4
    s_add_u32 s7, s7, s6
    s_lshl_b32 s7, s7, 12
    s_lshl_b32 s8, s6, 12
    s_add_u32 s8, s8, 7340032
    buffer_load_dwordx4 v[16:19], v15, s[44:47], s7 offen offset:0
    buffer_load_dwordx4 v[32:35], v15, s[44:47], s8 offen offset:0
    buffer_load_dwordx4 v[20:23], v15, s[44:47], s7 offen offset:1024
    buffer_load_dwordx4 v[36:39], v15, s[44:47], s8 offen offset:1024
    buffer_load_dwordx4 v[24:27], v15, s[44:47], s7 offen offset:2048
    buffer_load_dwordx4 v[40:43], v15, s[44:47], s8 offen offset:2048
    buffer_load_dwordx4 v[28:31], v15, s[44:47], s7 offen offset:3072
    buffer_load_dwordx4 v[44:47], v15, s[44:47], s8 offen offset:3072
    v_mov_b32 v48, 0
    v_mov_b32 v49, 0
    v_mov_b32 v50, 0
    v_mov_b32 v51, 0
    v_mov_b32 v52, 0
    v_mov_b32 v53, 0
    v_mov_b32 v54, 0
    v_mov_b32 v55, 0
    v_mov_b32 v56, 0
    v_mov_b32 v57, 0
    v_mov_b32 v58, 0
    v_mov_b32 v59, 0
    v_mov_b32 v60, 0
    v_mov_b32 v61, 0
    v_mov_b32 v62, 0
    v_mov_b32 v63, 0
    s_waitcnt vmcnt(0)
    v_mfma_f32_32x32x16_bf16 v[48:63], v[32:35], v[16:19], v[48:63]
    v_mfma_f32_32x32x16_bf16 v[48:63], v[36:39], v[20:23], v[48:63]
    v_mfma_f32_32x32x16_bf16 v[48:63], v[40:43], v[24:27], v[48:63]
    v_mfma_f32_32x32x16_bf16 v[48:63], v[44:47], v[28:31], v[48:63]
    s_nop 15
    v_cvt_pk_bf16_f32 v5, v60, v60
    v_lshlrev_b32 v5, 16, v5
    v_add_f32 v5, 0x358637bd, v5
    v_cvt_pk_bf16_f32 v5, v5, v5
    v_lshlrev_b32 v5, 16, v5
    v_mov_b32 v6, v5
    s_nop 1
    v_permlane32_swap_b32 v5, v6
    s_nop 1
    v_rcp_f32 v6, v6
    s_nop 0
    v_cvt_pk_bf16_f32 v7, v48, v49
    v_lshlrev_b32 v8, 16, v7
    v_and_b32 v9, 0xffff0000, v7
    v_mul_f32 v8, v8, v6
    v_mul_f32 v9, v9, v6
    v_cvt_pk_bf16_f32 v16, v8, v9
    v_cvt_pk_bf16_f32 v7, v50, v51
    v_lshlrev_b32 v8, 16, v7
    v_and_b32 v9, 0xffff0000, v7
    v_mul_f32 v8, v8, v6
    v_mul_f32 v9, v9, v6
    v_cvt_pk_bf16_f32 v17, v8, v9
    v_cvt_pk_bf16_f32 v7, v52, v53
    v_lshlrev_b32 v8, 16, v7
    v_and_b32 v9, 0xffff0000, v7
    v_mul_f32 v8, v8, v6
    v_mul_f32 v9, v9, v6
    v_cvt_pk_bf16_f32 v18, v8, v9
    v_cvt_pk_bf16_f32 v7, v54, v55
    v_lshlrev_b32 v8, 16, v7
    v_and_b32 v9, 0xffff0000, v7
    v_mul_f32 v8, v8, v6
    v_mul_f32 v9, v9, v6
    v_cvt_pk_bf16_f32 v19, v8, v9
    v_cvt_pk_bf16_f32 v7, v56, v57
    v_lshlrev_b32 v8, 16, v7
    v_and_b32 v9, 0xffff0000, v7
    v_mul_f32 v8, v8, v6
    v_mul_f32 v9, v9, v6
    v_cvt_pk_bf16_f32 v20, v8, v9
    v_cvt_pk_bf16_f32 v7, v58, v59
    v_lshlrev_b32 v8, 16, v7
    v_and_b32 v9, 0xffff0000, v7
    v_mul_f32 v8, v8, v6
    v_mul_f32 v9, v9, v6
    v_cvt_pk_bf16_f32 v21, v8, v9
    v_cvt_pk_bf16_f32 v7, v60, v61
    v_lshlrev_b32 v8, 16, v7
    v_and_b32 v9, 0xffff0000, v7
    v_mul_f32 v8, v8, v6
    v_mul_f32 v9, v9, v6
    v_cvt_pk_bf16_f32 v22, v8, v9
    v_cvt_pk_bf16_f32 v7, v62, v63
    v_lshlrev_b32 v8, 16, v7
    v_and_b32 v9, 0xffff0000, v7
    v_mul_f32 v8, v8, v6
    v_mul_f32 v9, v9, v6
    v_cvt_pk_bf16_f32 v23, v8, v9
    s_lshl_b32 s7, s6, 11
    v_add_u32 v5, s7, v15
    ds_write_b128 v5, v[16:19]
    ds_write_b128 v5, v[20:23] offset:1024
    s_waitcnt lgkmcnt(0)
    s_barrier
    s_mul_i32 s6, s5, 7
    s_add_u32 s6, s6, s3
    s_lshl_b32 s7, s6, 15
    s_add_u32 s7, s7, 8388608
    v_mov_b32 v48, 0
    v_mov_b32 v49, 0
    v_mov_b32 v50, 0
    v_mov_b32 v51, 0
    v_mov_b32 v52, 0
    v_mov_b32 v53, 0
    v_mov_b32 v54, 0
    v_mov_b32 v55, 0
    v_mov_b32 v56, 0
    v_mov_b32 v57, 0
    v_mov_b32 v58, 0
    v_mov_b32 v59, 0
    v_mov_b32 v60, 0
    v_mov_b32 v61, 0
    v_mov_b32 v62, 0
    v_mov_b32 v63, 0
    buffer_load_dwordx4 v[128:131], v15, s[44:47], s7 offen offset:0
    buffer_load_dwordx4 v[132:135], v15, s[44:47], s7 offen offset:1024
    buffer_load_dwordx4 v[136:139], v15, s[44:47], s7 offen offset:2048
    buffer_load_dwordx4 v[140:143], v15, s[44:47], s7 offen offset:3072
    s_add_u32 s7, s7, 4096
    buffer_load_dwordx4 v[144:147], v15, s[44:47], s7 offen offset:0
    buffer_load_dwordx4 v[148:151], v15, s[44:47], s7 offen offset:1024
    buffer_load_dwordx4 v[152:155], v15, s[44:47], s7 offen offset:2048
    buffer_load_dwordx4 v[156:159], v15, s[44:47], s7 offen offset:3072
    s_add_u32 s7, s7, 4096
    buffer_load_dwordx4 v[160:163], v15, s[44:47], s7 offen offset:0
    buffer_load_dwordx4 v[164:167], v15, s[44:47], s7 offen offset:1024
    buffer_load_dwordx4 v[168:171], v15, s[44:47], s7 offen offset:2048
    buffer_load_dwordx4 v[172:175], v15, s[44:47], s7 offen offset:3072
    s_add_u32 s7, s7, 4096
    buffer_load_dwordx4 v[176:179], v15, s[44:47], s7 offen offset:0
    buffer_load_dwordx4 v[180:183], v15, s[44:47], s7 offen offset:1024
    buffer_load_dwordx4 v[184:187], v15, s[44:47], s7 offen offset:2048
    buffer_load_dwordx4 v[188:191], v15, s[44:47], s7 offen offset:3072
    s_add_u32 s7, s7, 4096
    buffer_load_dwordx4 v[192:195], v15, s[44:47], s7 offen offset:0
    buffer_load_dwordx4 v[196:199], v15, s[44:47], s7 offen offset:1024
    buffer_load_dwordx4 v[200:203], v15, s[44:47], s7 offen offset:2048
    buffer_load_dwordx4 v[204:207], v15, s[44:47], s7 offen offset:3072
    s_add_u32 s7, s7, 4096
    buffer_load_dwordx4 v[208:211], v15, s[44:47], s7 offen offset:0
    buffer_load_dwordx4 v[212:215], v15, s[44:47], s7 offen offset:1024
    buffer_load_dwordx4 v[216:219], v15, s[44:47], s7 offen offset:2048
    buffer_load_dwordx4 v[220:223], v15, s[44:47], s7 offen offset:3072
    s_add_u32 s7, s7, 4096
    buffer_load_dwordx4 v[224:227], v15, s[44:47], s7 offen offset:0
    buffer_load_dwordx4 v[228:231], v15, s[44:47], s7 offen offset:1024
    buffer_load_dwordx4 v[232:235], v15, s[44:47], s7 offen offset:2048
    buffer_load_dwordx4 v[236:239], v15, s[44:47], s7 offen offset:3072
    s_add_u32 s7, s7, 4096
    buffer_load_dwordx4 v[240:243], v15, s[44:47], s7 offen offset:0
    buffer_load_dwordx4 v[244:247], v15, s[44:47], s7 offen offset:1024
    buffer_load_dwordx4 v[248:251], v15, s[44:47], s7 offen offset:2048
    buffer_load_dwordx4 v[252:255], v15, s[44:47], s7 offen offset:3072
    s_add_u32 s7, s7, 4096
    ds_read_b128 v[20:23], v15 offset:0
    s_waitcnt vmcnt(31) lgkmcnt(0)
    v_mfma_f32_32x32x16_bf16 v[48:63], v[128:131], v[20:23], v[48:63]
    ds_read_b128 v[24:27], v15 offset:1024
    s_waitcnt vmcnt(30) lgkmcnt(0)
    v_mfma_f32_32x32x16_bf16 v[48:63], v[132:135], v[24:27], v[48:63]
    ds_read_b128 v[20:23], v15 offset:2048
    s_waitcnt vmcnt(29) lgkmcnt(0)
    v_mfma_f32_32x32x16_bf16 v[48:63], v[136:139], v[20:23], v[48:63]
    ds_read_b128 v[24:27], v15 offset:3072
    s_waitcnt vmcnt(28) lgkmcnt(0)
    v_mfma_f32_32x32x16_bf16 v[48:63], v[140:143], v[24:27], v[48:63]
    ds_read_b128 v[20:23], v15 offset:4096
    s_waitcnt vmcnt(27) lgkmcnt(0)
    v_mfma_f32_32x32x16_bf16 v[48:63], v[144:147], v[20:23], v[48:63]
    ds_read_b128 v[24:27], v15 offset:5120
    s_waitcnt vmcnt(26) lgkmcnt(0)
    v_mfma_f32_32x32x16_bf16 v[48:63], v[148:151], v[24:27], v[48:63]
    ds_read_b128 v[20:23], v15 offset:6144
    s_waitcnt vmcnt(25) lgkmcnt(0)
    v_mfma_f32_32x32x16_bf16 v[48:63], v[152:155], v[20:23], v[48:63]
    ds_read_b128 v[24:27], v15 offset:7168
    s_waitcnt vmcnt(24) lgkmcnt(0)
    v_mfma_f32_32x32x16_bf16 v[48:63], v[156:159], v[24:27], v[48:63]
    ds_read_b128 v[20:23], v15 offset:8192
    s_waitcnt vmcnt(23) lgkmcnt(0)
    v_mfma_f32_32x32x16_bf16 v[48:63], v[160:163], v[20:23], v[48:63]
    ds_read_b128 v[24:27], v15 offset:9216
    s_waitcnt vmcnt(22) lgkmcnt(0)
    v_mfma_f32_32x32x16_bf16 v[48:63], v[164:167], v[24:27], v[48:63]
    ds_read_b128 v[20:23], v15 offset:10240
    s_waitcnt vmcnt(21) lgkmcnt(0)
    v_mfma_f32_32x32x16_bf16 v[48:63], v[168:171], v[20:23], v[48:63]
    ds_read_b128 v[24:27], v15 offset:11264
    s_waitcnt vmcnt(20) lgkmcnt(0)
    v_mfma_f32_32x32x16_bf16 v[48:63], v[172:175], v[24:27], v[48:63]
    ds_read_b128 v[20:23], v15 offset:12288
    s_waitcnt vmcnt(19) lgkmcnt(0)
    v_mfma_f32_32x32x16_bf16 v[48:63], v[176:179], v[20:23], v[48:63]
    ds_read_b128 v[24:27], v15 offset:13312
    s_waitcnt vmcnt(18) lgkmcnt(0)
    v_mfma_f32_32x32x16_bf16 v[48:63], v[180:183], v[24:27], v[48:63]
    ds_read_b128 v[20:23], v15 offset:14336
    s_waitcnt vmcnt(17) lgkmcnt(0)
    v_mfma_f32_32x32x16_bf16 v[48:63], v[184:187], v[20:23], v[48:63]
    ds_read_b128 v[24:27], v15 offset:15360
    s_waitcnt vmcnt(16) lgkmcnt(0)
    v_mfma_f32_32x32x16_bf16 v[48:63], v[188:191], v[24:27], v[48:63]
    ds_read_b128 v[20:23], v15 offset:16384
    s_waitcnt vmcnt(15) lgkmcnt(0)
    v_mfma_f32_32x32x16_bf16 v[48:63], v[192:195], v[20:23], v[48:63]
    ds_read_b128 v[24:27], v15 offset:17408
    s_waitcnt vmcnt(14) lgkmcnt(0)
    v_mfma_f32_32x32x16_bf16 v[48:63], v[196:199], v[24:27], v[48:63]
    ds_read_b128 v[20:23], v15 offset:18432
    s_waitcnt vmcnt(13) lgkmcnt(0)
    v_mfma_f32_32x32x16_bf16 v[48:63], v[200:203], v[20:23], v[48:63]
    ds_read_b128 v[24:27], v15 offset:19456
    s_waitcnt vmcnt(12) lgkmcnt(0)
    v_mfma_f32_32x32x16_bf16 v[48:63], v[204:207], v[24:27], v[48:63]
    ds_read_b128 v[20:23], v15 offset:20480
    s_waitcnt vmcnt(11) lgkmcnt(0)
    v_mfma_f32_32x32x16_bf16 v[48:63], v[208:211], v[20:23], v[48:63]
    ds_read_b128 v[24:27], v15 offset:21504
    s_waitcnt vmcnt(10) lgkmcnt(0)
    v_mfma_f32_32x32x16_bf16 v[48:63], v[212:215], v[24:27], v[48:63]
    ds_read_b128 v[20:23], v15 offset:22528
    s_waitcnt vmcnt(9) lgkmcnt(0)
    v_mfma_f32_32x32x16_bf16 v[48:63], v[216:219], v[20:23], v[48:63]
    ds_read_b128 v[24:27], v15 offset:23552
    s_waitcnt vmcnt(8) lgkmcnt(0)
    v_mfma_f32_32x32x16_bf16 v[48:63], v[220:223], v[24:27], v[48:63]
    ds_read_b128 v[20:23], v15 offset:24576
    s_waitcnt vmcnt(7) lgkmcnt(0)
    v_mfma_f32_32x32x16_bf16 v[48:63], v[224:227], v[20:23], v[48:63]
    ds_read_b128 v[24:27], v15 offset:25600
    s_waitcnt vmcnt(6) lgkmcnt(0)
    v_mfma_f32_32x32x16_bf16 v[48:63], v[228:231], v[24:27], v[48:63]
    ds_read_b128 v[20:23], v15 offset:26624
    s_waitcnt vmcnt(5) lgkmcnt(0)
    v_mfma_f32_32x32x16_bf16 v[48:63], v[232:235], v[20:23], v[48:63]
    ds_read_b128 v[24:27], v15 offset:27648
    s_waitcnt vmcnt(4) lgkmcnt(0)
    v_mfma_f32_32x32x16_bf16 v[48:63], v[236:239], v[24:27], v[48:63]
    ds_read_b128 v[20:23], v15 offset:28672
    s_waitcnt vmcnt(3) lgkmcnt(0)
    v_mfma_f32_32x32x16_bf16 v[48:63], v[240:243], v[20:23], v[48:63]
    ds_read_b128 v[24:27], v15 offset:29696
    s_waitcnt vmcnt(2) lgkmcnt(0)
    v_mfma_f32_32x32x16_bf16 v[48:63], v[244:247], v[24:27], v[48:63]
    ds_read_b128 v[20:23], v15 offset:30720
    s_waitcnt vmcnt(1) lgkmcnt(0)
    v_mfma_f32_32x32x16_bf16 v[48:63], v[248:251], v[20:23], v[48:63]
    ds_read_b128 v[24:27], v15 offset:31744
    s_waitcnt vmcnt(0) lgkmcnt(0)
    v_mfma_f32_32x32x16_bf16 v[48:63], v[252:255], v[24:27], v[48:63]
    s_nop 15
    s_lshl_b32 s7, s4, 5
    v_add_u32 v5, s7, v3
    v_mul_u32_u24 v5, 1792, v5
    v_lshl_add_u32 v5, v4, 3, v5
    s_lshl_b32 s7, s6, 6
    s_add_u32 s7, s7, 896
    v_cvt_pk_bf16_f32 v16, v48, v49
    v_cvt_pk_bf16_f32 v17, v50, v51
    buffer_store_dwordx2 v[16:17], v5, s[48:51], s7 offen offset:0
    s_nop 2
    v_cvt_pk_bf16_f32 v16, v52, v53
    v_cvt_pk_bf16_f32 v17, v54, v55
    buffer_store_dwordx2 v[16:17], v5, s[48:51], s7 offen offset:16
    s_nop 2
    v_cvt_pk_bf16_f32 v16, v56, v57
    v_cvt_pk_bf16_f32 v17, v58, v59
    buffer_store_dwordx2 v[16:17], v5, s[48:51], s7 offen offset:32
    s_nop 2
    v_cvt_pk_bf16_f32 v16, v60, v61
    v_cvt_pk_bf16_f32 v17, v62, v63
    buffer_store_dwordx2 v[16:17], v5, s[48:51], s7 offen offset:48
    s_nop 2
    s_mul_i32 s6, s5, 7
    s_add_u32 s6, s6, s3
    s_cmp_eq_u32 s3, 3
    s_cbranch_scc1 L_end2
    s_add_u32 s6, s6, 4
    s_lshl_b32 s7, s6, 15
    s_add_u32 s7, s7, 8388608
    v_mov_b32 v48, 0
    v_mov_b32 v49, 0
    v_mov_b32 v50, 0
    v_mov_b32 v51, 0
    v_mov_b32 v52, 0
    v_mov_b32 v53, 0
    v_mov_b32 v54, 0
    v_mov_b32 v55, 0
    v_mov_b32 v56, 0
    v_mov_b32 v57, 0
    v_mov_b32 v58, 0
    v_mov_b32 v59, 0
    v_mov_b32 v60, 0
    v_mov_b32 v61, 0
    v_mov_b32 v62, 0
    v_mov_b32 v63, 0
    buffer_load_dwordx4 v[128:131], v15, s[44:47], s7 offen offset:0
    buffer_load_dwordx4 v[132:135], v15, s[44:47], s7 offen offset:1024
    buffer_load_dwordx4 v[136:139], v15, s[44:47], s7 offen offset:2048
    buffer_load_dwordx4 v[140:143], v15, s[44:47], s7 offen offset:3072
    s_add_u32 s7, s7, 4096
    buffer_load_dwordx4 v[144:147], v15, s[44:47], s7 offen offset:0
    buffer_load_dwordx4 v[148:151], v15, s[44:47], s7 offen offset:1024
    buffer_load_dwordx4 v[152:155], v15, s[44:47], s7 offen offset:2048
    buffer_load_dwordx4 v[156:159], v15, s[44:47], s7 offen offset:3072
    s_add_u32 s7, s7, 4096
    buffer_load_dwordx4 v[160:163], v15, s[44:47], s7 offen offset:0
    buffer_load_dwordx4 v[164:167], v15, s[44:47], s7 offen offset:1024
    buffer_load_dwordx4 v[168:171], v15, s[44:47], s7 offen offset:2048
    buffer_load_dwordx4 v[172:175], v15, s[44:47], s7 offen offset:3072
    s_add_u32 s7, s7, 4096
    buffer_load_dwordx4 v[176:179], v15, s[44:47], s7 offen offset:0
    buffer_load_dwordx4 v[180:183], v15, s[44:47], s7 offen offset:1024
    buffer_load_dwordx4 v[184:187], v15, s[44:47], s7 offen offset:2048
    buffer_load_dwordx4 v[188:191], v15, s[44:47], s7 offen offset:3072
    s_add_u32 s7, s7, 4096
    buffer_load_dwordx4 v[192:195], v15, s[44:47], s7 offen offset:0
    buffer_load_dwordx4 v[196:199], v15, s[44:47], s7 offen offset:1024
    buffer_load_dwordx4 v[200:203], v15, s[44:47], s7 offen offset:2048
    buffer_load_dwordx4 v[204:207], v15, s[44:47], s7 offen offset:3072
    s_add_u32 s7, s7, 4096
    buffer_load_dwordx4 v[208:211], v15, s[44:47], s7 offen offset:0
    buffer_load_dwordx4 v[212:215], v15, s[44:47], s7 offen offset:1024
    buffer_load_dwordx4 v[216:219], v15, s[44:47], s7 offen offset:2048
    buffer_load_dwordx4 v[220:223], v15, s[44:47], s7 offen offset:3072
    s_add_u32 s7, s7, 4096
    buffer_load_dwordx4 v[224:227], v15, s[44:47], s7 offen offset:0
    buffer_load_dwordx4 v[228:231], v15, s[44:47], s7 offen offset:1024
    buffer_load_dwordx4 v[232:235], v15, s[44:47], s7 offen offset:2048
    buffer_load_dwordx4 v[236:239], v15, s[44:47], s7 offen offset:3072
    s_add_u32 s7, s7, 4096
    buffer_load_dwordx4 v[240:243], v15, s[44:47], s7 offen offset:0
    buffer_load_dwordx4 v[244:247], v15, s[44:47], s7 offen offset:1024
    buffer_load_dwordx4 v[248:251], v15, s[44:47], s7 offen offset:2048
    buffer_load_dwordx4 v[252:255], v15, s[44:47], s7 offen offset:3072
    s_add_u32 s7, s7, 4096
    ds_read_b128 v[20:23], v15 offset:0
    s_waitcnt vmcnt(31) lgkmcnt(0)
    v_mfma_f32_32x32x16_bf16 v[48:63], v[128:131], v[20:23], v[48:63]
    ds_read_b128 v[24:27], v15 offset:1024
    s_waitcnt vmcnt(30) lgkmcnt(0)
    v_mfma_f32_32x32x16_bf16 v[48:63], v[132:135], v[24:27], v[48:63]
    ds_read_b128 v[20:23], v15 offset:2048
    s_waitcnt vmcnt(29) lgkmcnt(0)
    v_mfma_f32_32x32x16_bf16 v[48:63], v[136:139], v[20:23], v[48:63]
    ds_read_b128 v[24:27], v15 offset:3072
    s_waitcnt vmcnt(28) lgkmcnt(0)
    v_mfma_f32_32x32x16_bf16 v[48:63], v[140:143], v[24:27], v[48:63]
    ds_read_b128 v[20:23], v15 offset:4096
    s_waitcnt vmcnt(27) lgkmcnt(0)
    v_mfma_f32_32x32x16_bf16 v[48:63], v[144:147], v[20:23], v[48:63]
    ds_read_b128 v[24:27], v15 offset:5120
    s_waitcnt vmcnt(26) lgkmcnt(0)
    v_mfma_f32_32x32x16_bf16 v[48:63], v[148:151], v[24:27], v[48:63]
    ds_read_b128 v[20:23], v15 offset:6144
    s_waitcnt vmcnt(25) lgkmcnt(0)
    v_mfma_f32_32x32x16_bf16 v[48:63], v[152:155], v[20:23], v[48:63]
    ds_read_b128 v[24:27], v15 offset:7168
    s_waitcnt vmcnt(24) lgkmcnt(0)
    v_mfma_f32_32x32x16_bf16 v[48:63], v[156:159], v[24:27], v[48:63]
    ds_read_b128 v[20:23], v15 offset:8192
    s_waitcnt vmcnt(23) lgkmcnt(0)
    v_mfma_f32_32x32x16_bf16 v[48:63], v[160:163], v[20:23], v[48:63]
    ds_read_b128 v[24:27], v15 offset:9216
    s_waitcnt vmcnt(22) lgkmcnt(0)
    v_mfma_f32_32x32x16_bf16 v[48:63], v[164:167], v[24:27], v[48:63]
    ds_read_b128 v[20:23], v15 offset:10240
    s_waitcnt vmcnt(21) lgkmcnt(0)
    v_mfma_f32_32x32x16_bf16 v[48:63], v[168:171], v[20:23], v[48:63]
    ds_read_b128 v[24:27], v15 offset:11264
    s_waitcnt vmcnt(20) lgkmcnt(0)
    v_mfma_f32_32x32x16_bf16 v[48:63], v[172:175], v[24:27], v[48:63]
    ds_read_b128 v[20:23], v15 offset:12288
    s_waitcnt vmcnt(19) lgkmcnt(0)
    v_mfma_f32_32x32x16_bf16 v[48:63], v[176:179], v[20:23], v[48:63]
    ds_read_b128 v[24:27], v15 offset:13312
    s_waitcnt vmcnt(18) lgkmcnt(0)
    v_mfma_f32_32x32x16_bf16 v[48:63], v[180:183], v[24:27], v[48:63]
    ds_read_b128 v[20:23], v15 offset:14336
    s_waitcnt vmcnt(17) lgkmcnt(0)
    v_mfma_f32_32x32x16_bf16 v[48:63], v[184:187], v[20:23], v[48:63]
    ds_read_b128 v[24:27], v15 offset:15360
    s_waitcnt vmcnt(16) lgkmcnt(0)
    v_mfma_f32_32x32x16_bf16 v[48:63], v[188:191], v[24:27], v[48:63]
    ds_read_b128 v[20:23], v15 offset:16384
    s_waitcnt vmcnt(15) lgkmcnt(0)
    v_mfma_f32_32x32x16_bf16 v[48:63], v[192:195], v[20:23], v[48:63]
    ds_read_b128 v[24:27], v15 offset:17408
    s_waitcnt vmcnt(14) lgkmcnt(0)
    v_mfma_f32_32x32x16_bf16 v[48:63], v[196:199], v[24:27], v[48:63]
    ds_read_b128 v[20:23], v15 offset:18432
    s_waitcnt vmcnt(13) lgkmcnt(0)
    v_mfma_f32_32x32x16_bf16 v[48:63], v[200:203], v[20:23], v[48:63]
    ds_read_b128 v[24:27], v15 offset:19456
    s_waitcnt vmcnt(12) lgkmcnt(0)
    v_mfma_f32_32x32x16_bf16 v[48:63], v[204:207], v[24:27], v[48:63]
    ds_read_b128 v[20:23], v15 offset:20480
    s_waitcnt vmcnt(11) lgkmcnt(0)
    v_mfma_f32_32x32x16_bf16 v[48:63], v[208:211], v[20:23], v[48:63]
    ds_read_b128 v[24:27], v15 offset:21504
    s_waitcnt vmcnt(10) lgkmcnt(0)
    v_mfma_f32_32x32x16_bf16 v[48:63], v[212:215], v[24:27], v[48:63]
    ds_read_b128 v[20:23], v15 offset:22528
    s_waitcnt vmcnt(9) lgkmcnt(0)
    v_mfma_f32_32x32x16_bf16 v[48:63], v[216:219], v[20:23], v[48:63]
    ds_read_b128 v[24:27], v15 offset:23552
    s_waitcnt vmcnt(8) lgkmcnt(0)
    v_mfma_f32_32x32x16_bf16 v[48:63], v[220:223], v[24:27], v[48:63]
    ds_read_b128 v[20:23], v15 offset:24576
    s_waitcnt vmcnt(7) lgkmcnt(0)
    v_mfma_f32_32x32x16_bf16 v[48:63], v[224:227], v[20:23], v[48:63]
    ds_read_b128 v[24:27], v15 offset:25600
    s_waitcnt vmcnt(6) lgkmcnt(0)
    v_mfma_f32_32x32x16_bf16 v[48:63], v[228:231], v[24:27], v[48:63]
    ds_read_b128 v[20:23], v15 offset:26624
    s_waitcnt vmcnt(5) lgkmcnt(0)
    v_mfma_f32_32x32x16_bf16 v[48:63], v[232:235], v[20:23], v[48:63]
    ds_read_b128 v[24:27], v15 offset:27648
    s_waitcnt vmcnt(4) lgkmcnt(0)
    v_mfma_f32_32x32x16_bf16 v[48:63], v[236:239], v[24:27], v[48:63]
    ds_read_b128 v[20:23], v15 offset:28672
    s_waitcnt vmcnt(3) lgkmcnt(0)
    v_mfma_f32_32x32x16_bf16 v[48:63], v[240:243], v[20:23], v[48:63]
    ds_read_b128 v[24:27], v15 offset:29696
    s_waitcnt vmcnt(2) lgkmcnt(0)
    v_mfma_f32_32x32x16_bf16 v[48:63], v[244:247], v[24:27], v[48:63]
    ds_read_b128 v[20:23], v15 offset:30720
    s_waitcnt vmcnt(1) lgkmcnt(0)
    v_mfma_f32_32x32x16_bf16 v[48:63], v[248:251], v[20:23], v[48:63]
    ds_read_b128 v[24:27], v15 offset:31744
    s_waitcnt vmcnt(0) lgkmcnt(0)
    v_mfma_f32_32x32x16_bf16 v[48:63], v[252:255], v[24:27], v[48:63]
    s_nop 15
    s_lshl_b32 s7, s4, 5
    v_add_u32 v5, s7, v3
    v_mul_u32_u24 v5, 1792, v5
    v_lshl_add_u32 v5, v4, 3, v5
    s_lshl_b32 s7, s6, 6
    s_add_u32 s7, s7, 896
    v_cvt_pk_bf16_f32 v16, v48, v49
    v_cvt_pk_bf16_f32 v17, v50, v51
    buffer_store_dwordx2 v[16:17], v5, s[48:51], s7 offen offset:0
    s_nop 2
    v_cvt_pk_bf16_f32 v16, v52, v53
    v_cvt_pk_bf16_f32 v17, v54, v55
    buffer_store_dwordx2 v[16:17], v5, s[48:51], s7 offen offset:16
    s_nop 2
    v_cvt_pk_bf16_f32 v16, v56, v57
    v_cvt_pk_bf16_f32 v17, v58, v59
    buffer_store_dwordx2 v[16:17], v5, s[48:51], s7 offen offset:32
    s_nop 2
    v_cvt_pk_bf16_f32 v16, v60, v61
    v_cvt_pk_bf16_f32 v17, v62, v63
    buffer_store_dwordx2 v[16:17], v5, s[48:51], s7 offen offset:48
    s_nop 2
L_end2:
    s_endpgm
.section .rodata,"a"
.p2align 6
.amdhsa_kernel concat_heads__ssm_conv_s4d__linear_kernel_hedgehog__prompt_kernel
  .amdhsa_next_free_vgpr 256
  .amdhsa_next_free_sgpr 102
  .amdhsa_accum_offset 256
  .amdhsa_group_segment_fixed_size 0
  .amdhsa_kernarg_size 112
  .amdhsa_user_sgpr_count 2
  .amdhsa_user_sgpr_kernarg_segment_ptr 1
  .amdhsa_system_sgpr_workgroup_id_x 1
.end_amdhsa_kernel
.p2align 6
.amdhsa_kernel concat_heads__ssm_conv_s4d__linear_kernel_hedgehog__prompt_s2_kernel
  .amdhsa_next_free_vgpr 256
  .amdhsa_next_free_sgpr 102
  .amdhsa_accum_offset 256
  .amdhsa_group_segment_fixed_size 0
  .amdhsa_kernarg_size 112
  .amdhsa_user_sgpr_count 2
  .amdhsa_user_sgpr_kernarg_segment_ptr 1
  .amdhsa_system_sgpr_workgroup_id_x 1
.end_amdhsa_kernel
```
